```python
import torch

def _softmax(x, axis=-1):
    return torch.softmax(x, dim=axis)

def _gelu(x):
    return torch.nn.functional.gelu(x, approximate='tanh')

def _silu(x):
    return torch.nn.functional.silu(x)

def _sigmoid(x):
    return torch.sigmoid(x)

def _layernorm(x, axis=-1, eps=1e-05):
    m = x.mean(dim=axis, keepdim=True)
    v = x.var(dim=axis, keepdim=True, unbiased=False)
    return (x - m) / torch.sqrt(v + eps)

def _scatter_add(tgt, idx, src, axis=0):
    return tgt.clone().index_add_(axis, idx, src)

def _segment_sum(src, seg, n):
    out = torch.zeros((n,) + src.shape[1:], dtype=src.dtype)
    return out.index_add_(0, seg, src)

def _pad(x, pw):
    flat = tuple((v for pair in reversed(pw) for v in pair))
    return torch.nn.functional.pad(x, flat)
kernel_name = 'adaLN_cond__sliding_local_dilated__swiglu_ffn__prompt'

def setup_inputs():

    _w = lambda a: (lambda t: t.to(torch.bfloat16) if t.is_floating_point() else t)(torch.as_tensor(a))

    def _A_setup():
        B, S, D = (1, 2048, 640)
        return {'x': _w((lambda *s: torch.randn(*s, dtype=torch.bfloat16) * 0.05)(B, S, D)), 'wqkv': _w((lambda *s: torch.randn(*s, dtype=torch.bfloat16) * 0.05)(D, 3 * D)), 'wo': _w((lambda *s: torch.randn(*s, dtype=torch.bfloat16) * 0.05)(D, D))}
    _A_in = _A_setup()

    def _B_setup():
        B, S, D, F = (1, 2048, 640, 1536)
        return {'x': _w((lambda *s: torch.randn(*s, dtype=torch.bfloat16) * 0.05)(B, S, D)), 'w_gate': _w((lambda *s: torch.randn(*s, dtype=torch.bfloat16) * 0.05)(D, F)), 'w_up': _w((lambda *s: torch.randn(*s, dtype=torch.bfloat16) * 0.05)(D, F)), 'w_down': _w((lambda *s: torch.randn(*s, dtype=torch.bfloat16) * 0.05)(F, D))}
    _B_in = _B_setup()
    return {'A_x': _A_in['x'], 'A_wqkv': _A_in['wqkv'], 'A_wo': _A_in['wo'], 'B_x': _B_in['x'], 'B_w_gate': _B_in['w_gate'], 'B_w_up': _B_in['w_up'], 'B_w_down': _B_in['w_down'], 'c': _w((lambda *s: torch.randn(*s, dtype=torch.bfloat16) * 0.1)(1, 640) * 8.0), 'w_mod': _w((lambda *s: torch.randn(*s, dtype=torch.bfloat16) * 0.1)(640, 6 * 640) * 640 ** (-0.5) * 8.0)}

def reference(A_x, A_wqkv, A_wo, B_x, B_w_gate, B_w_up, B_w_down, c, w_mod):

    def _A_ref(x, wqkv, wo):
        B, S, D = x.shape
        H = 32
        Dh = D // H
        W, dil = (8, 2)
        qkv = (lambda x, *d: x.permute(*d))((x @ wqkv).reshape(B, S, 3, H, Dh), 2, 0, 3, 1, 4)
        q, k, v = (qkv[0], qkv[1], qkv[2])
        scale = Dh ** (-0.5)
        pos = torch.arange(S)
        off = torch.arange(W) * dil
        idx = pos[:, None] - off[None, :]
        mask = idx >= 0
        idx_c = torch.where(mask, idx, 0).reshape(-1)
        kg = k[:, :, idx_c, :].reshape(B, H, S, W, Dh)
        vg = v[:, :, idx_c, :].reshape(B, H, S, W, Dh)
        logits = torch.einsum('bhsd,bhswd->bhsw', q, kg) * scale
        logits = torch.where(mask[None, None, :, :], logits, -1000000000.0)
        attn = _softmax(logits, axis=-1)
        o = torch.einsum('bhsw,bhswd->bhsd', attn, vg)
        return (lambda x, *d: x.permute(*d))(o, 0, 2, 1, 3).reshape(B, S, D) @ wo

    def _B_ref(x, w_gate, w_up, w_down):
        g = _silu(x @ w_gate)
        u = x @ w_up
        return g * u @ w_down
    x = A_x
    mod = (_silu(c) @ w_mod).reshape(c.shape[0], 6, 1, -1)
    sa, ca, ga, sb, cb, gb = (mod[:, 0].clone(), mod[:, 1].clone(), mod[:, 2].clone(), mod[:, 3].clone(), mod[:, 4].clone(), mod[:, 5].clone())
    h = _layernorm(x, axis=-1) * (1 + ca) + sa
    x = x + ga * _A_ref(h, A_wqkv, A_wo)
    h = _layernorm(x, axis=-1) * (1 + cb) + sb
    x = x + gb * _B_ref(h, B_w_gate, B_w_up, B_w_down)
    return x
```

```asm
; @launch grid=(256,1,1) block=(256,1,1) lds=163840
.amdgcn_target "amdgcn-amd-amdhsa--gfx950"
.text
.globl adaLN_cond__sliding_local_dilated__swiglu_ffn__prompt_kernel
.p2align 8
.type adaLN_cond__sliding_local_dilated__swiglu_ffn__prompt_kernel,@function
adaLN_cond__sliding_local_dilated__swiglu_ffn__prompt_kernel:
  s_load_dwordx16 s[8:23], s[0:1], 0
  s_load_dwordx8 s[24:31], s[0:1], 64
  s_cmpk_ge_u32 s2, 256
  s_cbranch_scc1 L_end
  s_getpc_b64 s[60:61]
  s_mov_b32 s62, 33764
  s_mov_b32 s63, 0x20000
  v_and_b32 v1, 63, v0
  v_lshrrev_b32 v10, 6, v0
  v_and_b32 v6, 15, v0
  v_min_u32 v11, 3, v1
  v_lshl_add_u32 v11, v10, 2, v11
  v_lshlrev_b32 v11, 7, v11
  s_lshr_b32 s5, s2, 3
  s_lshl_b32 s5, s5, 11
  v_readfirstlane_b32 s3, v10
  buffer_load_dword v9, v11, s[60:63], s5 offen
  s_and_b32 s68, s2, 3
  s_lshl_b32 s68, s68, 2
  s_add_u32 s68, s68, s3
  s_mul_i32 s68, s68, 40
  s_mul_i32 s69, s68, 7680
  s_sub_u32 s75, s2, 120
  s_cmpk_lt_u32 s2, 80
  s_cselect_b32 s75, s2, s75
  s_lshr_b32 s76, s75, 2
  s_lshl_b32 s74, s76, 7
  s_add_u32 s74, s74, s69
  s_movk_i32 s72, 7680
  s_mov_b32 s46, 4915200
  s_mov_b32 s71, 61440
  s_sub_u32 s78, s2, 80
  s_mul_i32 s79, s78, 10923
  s_lshr_b32 s79, s79, 16
  s_mul_i32 s6, s79, 6
  s_sub_u32 s83, s78, s6
  s_lshr_b32 s6, s79, 1
  s_mul_i32 s6, s6, 10
  s_and_b32 s7, s79, 1
  s_lshl_b32 s7, s7, 2
  s_add_u32 s6, s6, s7
  s_add_u32 s6, s6, s3
  s_mul_i32 s7, s79, 20
  s_sub_u32 s7, s7, 312
  s_lshr_b32 s5, s3, 1
  s_lshl_b32 s5, s5, 3
  s_add_u32 s7, s7, s5
  s_add_u32 s7, s7, s3
  s_cmpk_lt_u32 s79, 16
  s_cselect_b32 s6, s6, s7
  s_mul_i32 s6, s6, 48
  s_add_u32 s6, s6, s83
  s_mul_i32 s6, s6, 640
  s_cmpk_lt_u32 s78, 120
  s_cselect_b32 s74, s6, s74
  s_cselect_b32 s76, s79, s76
  s_cselect_b32 s72, 3840, s72
  s_cselect_b32 s46, 2457600, s46
  s_cselect_b32 s71, 128, s71
  v_lshrrev_b32 v14, 3, v1
  v_and_b32 v17, 7, v1
  v_lshlrev_b32 v15, 4, v17
  v_mad_u32_u24 v40, v14, s72, v15
  v_lshlrev_b32 v2, 4, v1
  v_lshlrev_b32 v13, 1, v1
  s_lshl_b32 s7, s68, 1
  v_mov_b32 v8, 0
  v_lshrrev_b32 v5, 4, v1
  v_lshrrev_b32 v18, 5, v1
  s_mov_b32 s34, 37748736
  s_mov_b32 s35, s63
  s_movk_i32 s58, 1280
  s_mov_b32 s59, s63
  s_mov_b32 s47, s63
  s_mov_b32 s38, 2621440
  s_mov_b32 s39, s63
  s_waitcnt lgkmcnt(0)
  s_mov_b64 s[56:57], s[22:23]
  s_mov_b64 s[32:33], s[30:31]
  s_mov_b64 s[36:37], s[8:9]
  s_cmpk_lt_u32 s78, 120
  s_cselect_b64 s[44:45], s[10:11], s[24:25]
  buffer_load_ushort v20, v13, s[56:59], s7 offen
  buffer_load_dword v8, v8, s[32:35], 0 offen sc1
  buffer_load_dwordx4 v[64:67], v40, s[44:47], s74 offen nt
  s_add_u32 s74, s74, s71
  buffer_load_dwordx4 v[68:71], v40, s[44:47], s74 offen nt
  s_add_u32 s74, s74, s71
  buffer_load_dwordx4 v[72:75], v40, s[44:47], s74 offen nt
  s_add_u32 s74, s74, s71
  buffer_load_dwordx4 v[76:79], v40, s[44:47], s74 offen nt
  s_add_u32 s74, s74, s71
  buffer_load_dwordx4 v[80:83], v40, s[44:47], s74 offen nt
  s_lshr_b32 s7, s2, 3
  s_bfe_u32 s5, s2, 0x20001
  s_and_b32 s6, s2, 1
  s_and_b32 s66, s2, 7
  s_lshl_b32 s66, s66, 2
  s_lshr_b32 s88, s7, 3
  s_add_u32 s66, s66, s88
  s_and_b32 s67, s7, 7
  s_bfe_u32 s5, s2, 0x10002
  s_and_b32 s6, s2, 3
  s_lshl_b32 s64, s5, 3
  s_lshr_b32 s88, s7, 2
  s_add_u32 s64, s64, s88
  s_lshl_b32 s65, s6, 2
  s_and_b32 s88, s7, 3
  s_add_u32 s65, s65, s88
  s_lshl_b32 s5, s66, 2
  s_add_u32 s5, s5, s3
  s_mul_i32 s89, s5, 20480
  s_mul_i32 s77, s5, 20480
  s_mul_i32 s6, s67, 160
  s_add_u32 s77, s77, s6
  v_mul_u32_u24 v42, 1280, v6
  v_lshl_add_u32 v43, v5, 3, v42
  v_lshl_add_u32 v42, v5, 4, v42
  v_add_u32 v49, 0, v1
  v_mul_u32_u24 v50, 6554, v49
  v_lshrrev_b32 v50, 16, v50
  v_mul_u32_u24 v46, 1120, v50
  v_lshl_add_u32 v46, v49, 4, v46
  v_add_u32 v49, 64, v1
  v_mul_u32_u24 v50, 6554, v49
  v_lshrrev_b32 v50, 16, v50
  v_mul_u32_u24 v47, 1120, v50
  v_lshl_add_u32 v47, v49, 4, v47
  v_add_u32 v49, 128, v1
  v_mul_u32_u24 v50, 6554, v49
  v_lshrrev_b32 v50, 16, v50
  v_mul_u32_u24 v48, 1120, v50
  v_lshl_add_u32 v48, v49, 4, v48
  s_mul_i32 s5, s3, 3072
  s_add_u32 s5, s5, 93184
  s_mov_b32 m0, s5
  v_mul_u32_u24 v42, 160, v6
  v_add_u32 v42, s5, v42
  v_lshl_add_u32 v43, v5, 3, v42
  v_lshl_add_u32 v42, v5, 4, v42
  v_mad_u32_u24 v53, v14, 42, v17
  v_lshlrev_b32 v53, 4, v53
  s_mul_i32 s5, s3, 5504
  s_add_u32 s5, s5, 105472
  v_add_u32 v53, s5, v53
  v_bfe_u32 v54, v1, 2, 2
  v_mul_u32_u24 v54, 672, v54
  s_movk_i32 s5, 5504
  v_mad_u32_u24 v54, v5, s5, v54
  v_and_b32 v16, 3, v1
  s_mul_i32 s5, s3, 160
  s_add_u32 s5, s5, 105472
  v_add_u32 v54, s5, v54
  v_lshl_add_u32 v56, v16, 4, v54
  v_lshl_add_u32 v57, v16, 3, v54
  v_mad_u32_u24 v58, v16, 40, v54
  s_lshl_b32 s5, s66, 2
  s_add_u32 s5, s5, s3
  s_lshl_b32 s5, s5, 11
  s_add_u32 s70, s5, 524288
  s_lshl_b32 s5, s67, 8
  s_add_u32 s73, s70, s5
  s_cmpk_lt_u32 s78, 120
  s_cbranch_scc1 ROLEQ_1
  s_sub_u32 s5, s75, 96
  s_cmpk_lt_u32 s75, 96
  s_cselect_b32 s5, s75, s5
  s_lshr_b32 s84, s5, 1
  s_and_b32 s85, s5, 1
  s_lshl_b32 s7, s84, 2
  s_add_u32 s7, s7, s3
  s_lshl_b32 s90, s7, 3
  s_mul_i32 s6, s84, 10
  s_add_u32 s6, s6, s3
  s_lshl_b32 s6, s6, 2
  s_mul_i32 s7, s7, 40
  s_sub_u32 s7, s7, 2544
  s_cmpk_lt_u32 s84, 16
  s_cselect_b32 s6, s6, s7
  s_movk_i32 s86, 0
  s_mov_b32 s50, 1966080
  s_mov_b32 s51, s63
  s_cmpk_ge_u32 s75, 96
  s_cselect_b32 s90, s6, s90
  s_cselect_b64 s[48:49], s[12:13], s[20:21]
  s_cselect_b32 s50, 819200, s50
  s_cselect_b32 s6, 20480, s86
  s_lshl_b32 s90, s90, 1
  s_add_u32 s90, s90, s85
  s_mul_i32 s90, s90, 640
  v_mul_u32_u24 v41, 1280, v14
  v_add_u32 v41, v15, v41
  v_mad_u32_u24 v41, v18, s6, v41
  v_lshlrev_b32 v12, 2, v14
  v_and_b32 v10, 7, v1
  v_lshlrev_b32 v10, 5, v10
  v_lshl_add_u32 v10, v5, 3, v10
  s_lshl_b32 s5, s3, 8
  s_add_u32 s5, s5, 159744
  v_add_u32 v10, s5, v10
  v_lshlrev_b32 v11, 2, v1
  v_add_u32 v11, 159744, v11
  s_and_b32 s5, s2, 3
  s_mul_i32 s5, s5, 30720
  s_lshl_b32 s6, s76, 9
  s_add_u32 s5, s5, s6
  s_add_u32 s79, s5, 131072
  s_lshl_b32 s6, s3, 4
  s_lshl_b64 s[94:95], 0xffff, s6
  s_waitcnt vmcnt(5)
  v_readfirstlane_b32 s5, v8
  v_lshlrev_b32 v20, 16, v20
  v_mul_f32 v26, 0xbfb8aa3b, v20
  v_exp_f32 v26, v26
  s_mul_i32 s4, s5, 0x19660D
  s_add_u32 s4, s4, 0x3C6EF35F
  v_add_f32 v26, 1.0, v26
  v_rcp_f32 v26, v26
  v_mov_b32 v235, s4
  v_mul_f32 v26, v20, v26
  v_cvt_pk_bf16_f32 v26, v26, v26
  v_and_b32 v234, 0xffff0000, v26
  ds_bpermute_b32 v20, v12, v234 offset:0
  ds_bpermute_b32 v21, v12, v234 offset:32
  ds_bpermute_b32 v22, v12, v234 offset:64
  ds_bpermute_b32 v23, v12, v234 offset:96
  ds_bpermute_b32 v24, v12, v234 offset:128
  s_waitcnt vmcnt(3)
  buffer_load_dwordx4 v46, s[36:39], s77 offen lds
  s_add_u32 m0, m0, 1024
  s_nop 0
  buffer_load_dwordx4 v47, s[36:39], s77 offen lds
  s_add_u32 m0, m0, 1024
  s_mov_b32 exec_hi, 0
  buffer_load_dwordx4 v48, s[36:39], s77 offen lds
  s_mov_b64 exec, -1
  s_waitcnt vmcnt(7) lgkmcnt(0)
  v_lshlrev_b32 v148, 16, v64
  v_and_b32 v149, 0xffff0000, v64
  v_pk_mul_f32 v[140:141], v[20:21], v[148:149] op_sel_hi:[0,1]
  v_lshlrev_b32 v148, 16, v65
  v_and_b32 v149, 0xffff0000, v65
  v_pk_mul_f32 v[142:143], v[20:21], v[148:149] op_sel_hi:[0,1]
  v_lshlrev_b32 v148, 16, v66
  v_and_b32 v149, 0xffff0000, v66
  v_pk_mul_f32 v[144:145], v[20:21], v[148:149] op_sel_hi:[0,1]
  v_lshlrev_b32 v148, 16, v67
  v_and_b32 v149, 0xffff0000, v67
  v_pk_mul_f32 v[146:147], v[20:21], v[148:149] op_sel_hi:[0,1]
  s_waitcnt vmcnt(6)
  v_lshlrev_b32 v148, 16, v68
  v_and_b32 v149, 0xffff0000, v68
  v_pk_fma_f32 v[140:141], v[20:21], v[148:149], v[140:141] op_sel:[1,0,0]
  v_lshlrev_b32 v148, 16, v69
  v_and_b32 v149, 0xffff0000, v69
  v_pk_fma_f32 v[142:143], v[20:21], v[148:149], v[142:143] op_sel:[1,0,0]
  v_lshlrev_b32 v148, 16, v70
  v_and_b32 v149, 0xffff0000, v70
  v_pk_fma_f32 v[144:145], v[20:21], v[148:149], v[144:145] op_sel:[1,0,0]
  v_lshlrev_b32 v148, 16, v71
  v_and_b32 v149, 0xffff0000, v71
  v_pk_fma_f32 v[146:147], v[20:21], v[148:149], v[146:147] op_sel:[1,0,0]
  s_waitcnt vmcnt(5)
  v_lshlrev_b32 v148, 16, v72
  v_and_b32 v149, 0xffff0000, v72
  v_pk_fma_f32 v[140:141], v[22:23], v[148:149], v[140:141] op_sel_hi:[0,1,1]
  v_lshlrev_b32 v148, 16, v73
  v_and_b32 v149, 0xffff0000, v73
  v_pk_fma_f32 v[142:143], v[22:23], v[148:149], v[142:143] op_sel_hi:[0,1,1]
  v_lshlrev_b32 v148, 16, v74
  v_and_b32 v149, 0xffff0000, v74
  v_pk_fma_f32 v[144:145], v[22:23], v[148:149], v[144:145] op_sel_hi:[0,1,1]
  v_lshlrev_b32 v148, 16, v75
  v_and_b32 v149, 0xffff0000, v75
  v_pk_fma_f32 v[146:147], v[22:23], v[148:149], v[146:147] op_sel_hi:[0,1,1]
  s_waitcnt vmcnt(4)
  v_lshlrev_b32 v148, 16, v76
  v_and_b32 v149, 0xffff0000, v76
  v_pk_fma_f32 v[140:141], v[22:23], v[148:149], v[140:141] op_sel:[1,0,0]
  v_lshlrev_b32 v148, 16, v77
  v_and_b32 v149, 0xffff0000, v77
  v_pk_fma_f32 v[142:143], v[22:23], v[148:149], v[142:143] op_sel:[1,0,0]
  v_lshlrev_b32 v148, 16, v78
  v_and_b32 v149, 0xffff0000, v78
  v_pk_fma_f32 v[144:145], v[22:23], v[148:149], v[144:145] op_sel:[1,0,0]
  v_lshlrev_b32 v148, 16, v79
  v_and_b32 v149, 0xffff0000, v79
  v_pk_fma_f32 v[146:147], v[22:23], v[148:149], v[146:147] op_sel:[1,0,0]
  s_waitcnt vmcnt(3)
  v_lshlrev_b32 v148, 16, v80
  v_and_b32 v149, 0xffff0000, v80
  v_pk_fma_f32 v[140:141], v[24:25], v[148:149], v[140:141] op_sel_hi:[0,1,1]
  v_lshlrev_b32 v148, 16, v81
  v_and_b32 v149, 0xffff0000, v81
  v_pk_fma_f32 v[142:143], v[24:25], v[148:149], v[142:143] op_sel_hi:[0,1,1]
  v_lshlrev_b32 v148, 16, v82
  v_and_b32 v149, 0xffff0000, v82
  v_pk_fma_f32 v[144:145], v[24:25], v[148:149], v[144:145] op_sel_hi:[0,1,1]
  v_lshlrev_b32 v148, 16, v83
  v_and_b32 v149, 0xffff0000, v83
  v_pk_fma_f32 v[146:147], v[24:25], v[148:149], v[146:147] op_sel_hi:[0,1,1]
  v_permlane32_swap_b32 v140, v144
  v_permlane32_swap_b32 v141, v145
  v_permlane32_swap_b32 v142, v146
  v_permlane32_swap_b32 v143, v147
  v_pk_add_f32 v[140:141], v[140:141], v[144:145]
  v_pk_add_f32 v[142:143], v[142:143], v[146:147]
  s_nop 1
  v_permlane16_swap_b32 v140, v142
  v_permlane16_swap_b32 v141, v143
  v_pk_add_f32 v[140:141], v[140:141], v[142:143]
  s_nop 1
  v_add_f32_dpp v142, v140, v140 row_ror:8 row_mask:0xf bank_mask:0xf
  v_add_f32_dpp v143, v141, v141 row_ror:8 row_mask:0xf bank_mask:0xf
  ds_write_b64 v10, v[142:143]
  v_lshlrev_b32 v148, 3, v1
  v_mov_b32 v145, s4
  s_waitcnt lgkmcnt(0)
  s_barrier
  ds_read2st64_b32 v[140:141], v11 offset0:0 offset1:1
  ds_read2st64_b32 v[142:143], v11 offset0:2 offset1:3
  s_waitcnt lgkmcnt(0)
  v_add_f32 v140, v140, v141
  v_add_f32 v142, v142, v143
  v_add_f32 v144, v140, v142
  s_mov_b64 exec, s[94:95]
  buffer_store_dwordx2 v[144:145], v148, s[32:35], s79 offen sc1
  s_mov_b64 exec, -1
  buffer_load_dwordx4 v[88:91], v41, s[48:51], s90 offen offset:0 nt
  buffer_load_dwordx4 v[92:95], v41, s[48:51], s90 offen offset:128 nt
  buffer_load_dwordx4 v[96:99], v41, s[48:51], s90 offen offset:256 nt
  buffer_load_dwordx4 v[100:103], v41, s[48:51], s90 offen offset:384 nt
  buffer_load_dwordx4 v[104:107], v41, s[48:51], s90 offen offset:512 nt
  s_lshl_b32 s5, s85, 2
  s_add_u32 s5, s5, s3
  s_mov_b32 s7, 24117248
  s_cmpk_ge_u32 s75, 96
  s_cselect_b32 s6, 20, 48
  s_cselect_b32 s7, 18874368, s7
  s_cselect_b32 s94, 2, 0
  s_mul_i32 s5, s5, s6
  s_add_u32 s5, s5, s84
  s_mul_i32 s5, s5, 5120
  s_add_u32 s5, s5, s7
  s_add_u32 s94, s94, s85
  s_lshl_b32 s94, s94, 6
  s_add_u32 s94, s94, s84
  s_lshl_b32 s94, s94, 7
  s_add_u32 s6, s94, 851968
  s_cmpk_ge_u32 s75, 96
  s_cselect_b32 s48, 117440512, s5
  s_cselect_b32 s50, s5, 117440512
  s_cselect_b32 s94, 117440512, s6
  s_cselect_b32 s95, s6, 117440512
  s_mov_b32 s91, 117440512
  s_waitcnt vmcnt(6)
  s_branch BG_2
ROLEQ_1:
  s_and_b32 s5, s83, 1
  s_lshl_b32 s5, s5, 2
  s_add_u32 s5, s5, s3
  s_mul_i32 s7, s5, 40
  s_add_u32 s7, s7, s76
  s_mul_i32 s7, s7, 7680
  s_add_u32 s7, s7, 16252928
  s_lshl_b32 s5, s5, 6
  s_lshr_b32 s6, s78, 1
  s_add_u32 s5, s5, s6
  s_lshl_b32 s5, s5, 7
  s_add_u32 s91, s5, 1835008
  s_lshr_b32 s6, s83, 1
  s_lshl_b32 s79, s6, 11
  s_lshl_b32 s80, s6, 7
  s_add_u32 s80, s80, 4096
  s_movk_i32 s81, 256
  s_cmp_eq_u32 s6, 2
  s_cselect_b32 s79, 5120, s79
  s_cselect_b32 s80, 7168, s80
  s_cselect_b32 s81, 128, s81
  v_lshrrev_b32 v16, 3, v6
  v_mul_u32_u24 v16, 153600, v16
  v_mad_u32_u24 v16, v5, s81, v16
  v_add_u32 v16, v15, v16
  s_add_u32 s79, s79, s7
  s_add_u32 s80, s80, s7
  s_add_u32 s81, s79, 153600
  s_mov_b32 s48, 117440512
  s_mov_b32 s50, s48
  s_mov_b32 s94, s48
  s_mov_b32 s95, s48
  s_waitcnt vmcnt(5)
  v_readfirstlane_b32 s5, v8
  v_lshlrev_b32 v20, 16, v20
  v_mul_f32 v26, 0xbfb8aa3b, v20
  v_exp_f32 v26, v26
  s_mul_i32 s4, s5, 0x19660D
  s_add_u32 s4, s4, 0x3C6EF35F
  v_add_f32 v26, 1.0, v26
  v_rcp_f32 v26, v26
  v_mov_b32 v235, s4
  v_mul_f32 v26, v20, v26
  v_cvt_pk_bf16_f32 v26, v26, v26
  v_and_b32 v234, 0xffff0000, v26
  s_waitcnt vmcnt(3)
  buffer_load_dwordx4 v46, s[36:39], s77 offen lds
  s_add_u32 m0, m0, 1024
  s_nop 0
  buffer_load_dwordx4 v47, s[36:39], s77 offen lds
  s_add_u32 m0, m0, 1024
  s_mov_b32 exec_hi, 0
  buffer_load_dwordx4 v48, s[36:39], s77 offen lds
  s_mov_b64 exec, -1
  s_waitcnt vmcnt(7)
  ds_write_b128 v53, v[64:67] offset:0
  s_waitcnt vmcnt(6)
  ds_write_b128 v53, v[68:71] offset:128
  s_waitcnt vmcnt(5)
  ds_write_b128 v53, v[72:75] offset:256
  s_waitcnt vmcnt(4)
  ds_write_b128 v53, v[76:79] offset:384
  s_waitcnt vmcnt(3)
  ds_write_b128 v53, v[80:83] offset:512
  s_waitcnt lgkmcnt(0)
  s_barrier
  ds_read_b64_tr_b16 v[64:65], v57 offset:0
  ds_read_b64_tr_b16 v[66:67], v57 offset:2688
  ds_read_b64_tr_b16 v[68:69], v57 offset:40
  ds_read_b64_tr_b16 v[70:71], v57 offset:2728
  ds_read_b64_tr_b16 v[72:73], v57 offset:80
  ds_read_b64_tr_b16 v[74:75], v57 offset:2768
  ds_read_b64_tr_b16 v[76:77], v57 offset:120
  ds_read_b64_tr_b16 v[78:79], v57 offset:2808
  ds_read_b64_tr_b16 v[80:81], v58 offset:32
  ds_read_b64_tr_b16 v[82:83], v58 offset:2720
  s_waitcnt lgkmcnt(8)
  buffer_store_dwordx4 v[64:67], v2, s[32:35], s79 offen offset:0 sc1
  s_waitcnt lgkmcnt(6)
  buffer_store_dwordx4 v[68:71], v2, s[32:35], s79 offen offset:1024 sc1
  s_waitcnt lgkmcnt(4)
  buffer_store_dwordx4 v[72:75], v2, s[32:35], s81 offen offset:0 sc1
  s_waitcnt lgkmcnt(2)
  buffer_store_dwordx4 v[76:79], v2, s[32:35], s81 offen offset:1024 sc1
  s_waitcnt lgkmcnt(0)
  buffer_store_dwordx4 v[80:83], v16, s[32:35], s80 offen sc1
  s_waitcnt vmcnt(5)
BG_2:
  ds_read_b128 v[128:131], v42
  ds_read_b128 v[132:135], v42 offset:64
  ds_read_b64 v[136:137], v43 offset:128
  s_waitcnt lgkmcnt(0)
  s_mov_b32 s5, 0x3f803f80
  v_dot2_f32_bf16 v28, v128, s5, 0
  v_dot2_f32_bf16 v30, v128, v128, 0
  v_dot2_f32_bf16 v29, v129, s5, 0
  v_dot2_f32_bf16 v31, v129, v129, 0
  v_dot2_f32_bf16 v28, v130, s5, v28
  v_dot2_f32_bf16 v30, v130, v130, v30
  v_dot2_f32_bf16 v29, v131, s5, v29
  v_dot2_f32_bf16 v31, v131, v131, v31
  v_dot2_f32_bf16 v28, v132, s5, v28
  v_dot2_f32_bf16 v30, v132, v132, v30
  v_dot2_f32_bf16 v29, v133, s5, v29
  v_dot2_f32_bf16 v31, v133, v133, v31
  v_dot2_f32_bf16 v28, v134, s5, v28
  v_dot2_f32_bf16 v30, v134, v134, v30
  v_dot2_f32_bf16 v29, v135, s5, v29
  v_dot2_f32_bf16 v31, v135, v135, v31
  v_dot2_f32_bf16 v28, v136, s5, v28
  v_dot2_f32_bf16 v30, v136, v136, v30
  v_dot2_f32_bf16 v29, v137, s5, v29
  v_dot2_f32_bf16 v31, v137, v137, v31
  v_mov_b32 v25, s4
  v_mov_b32 v27, s4
  s_add_u32 s49, s48, 4096
  v_add_f32 v24, v28, v29
  v_add_f32 v26, v30, v31
  v_mov_b32 v28, v24
  v_mov_b32 v29, v26
  s_nop 0
  v_permlane32_swap_b32 v24, v28
  v_permlane32_swap_b32 v26, v29
  v_add_f32 v24, v24, v28
  v_add_f32 v26, v26, v29
  v_mov_b32 v28, v24
  v_mov_b32 v29, v26
  s_nop 0
  v_permlane16_swap_b32 v24, v28
  v_permlane16_swap_b32 v26, v29
  v_add_f32 v24, v24, v28
  v_add_f32 v26, v26, v29
  s_mov_b64 exec, 0xffff
  buffer_store_dwordx4 v[24:27], v2, s[32:35], s73 offen sc1
  s_mov_b64 exec, -1
  v_accvgpr_write_b32 a240, v128
  v_lshlrev_b32 v140, 16, v128
  v_and_b32 v141, 0xffff0000, v128
  v_accvgpr_write_b32 a241, v129
  v_lshlrev_b32 v142, 16, v129
  v_and_b32 v143, 0xffff0000, v129
  v_accvgpr_write_b32 a242, v130
  v_lshlrev_b32 v144, 16, v130
  v_and_b32 v145, 0xffff0000, v130
  v_accvgpr_write_b32 a243, v131
  v_lshlrev_b32 v146, 16, v131
  v_and_b32 v147, 0xffff0000, v131
  v_accvgpr_write_b32 a244, v132
  v_lshlrev_b32 v148, 16, v132
  v_and_b32 v149, 0xffff0000, v132
  v_accvgpr_write_b32 a245, v133
  v_lshlrev_b32 v150, 16, v133
  v_and_b32 v151, 0xffff0000, v133
  v_accvgpr_write_b32 a246, v134
  v_lshlrev_b32 v152, 16, v134
  v_and_b32 v153, 0xffff0000, v134
  v_accvgpr_write_b32 a247, v135
  v_lshlrev_b32 v154, 16, v135
  v_and_b32 v155, 0xffff0000, v135
  v_accvgpr_write_b32 a248, v136
  v_lshlrev_b32 v156, 16, v136
  v_and_b32 v157, 0xffff0000, v136
  v_accvgpr_write_b32 a249, v137
  v_lshlrev_b32 v158, 16, v137
  v_and_b32 v159, 0xffff0000, v137
  s_lshl_b32 s5, s67, 11
  s_add_u32 s58, s89, s5
  s_add_u32 s58, s58, 2097152
  s_lshl_b32 s5, s67, 9
  s_add_u32 s59, s89, s5
  s_add_u32 s59, s59, 2113536
  s_mov_b32 s60, s70
  s_lshl_b32 s5, s66, 3
  s_add_u32 s5, s5, s67
  s_lshl_b32 s5, s5, 2
  s_add_u32 s5, s5, s3
  s_lshl_b32 s5, s5, 7
  s_add_u32 s79, s5, 1900544
  s_cmpk_ge_u32 s78, 120
  s_cbranch_scc1 NOQ_3
  s_waitcnt vmcnt(1)
  s_mov_b64 exec, 1
  buffer_store_dword v235, v2, s[32:35], s91 offen sc1
  s_mov_b64 exec, -1
NOQ_3:
  s_lshr_b32 s6, s65, 1
  s_lshl_b32 s6, s6, 13
  s_add_u32 s63, s6, 1835008
  v_min_u32 v32, 14, v1
  v_mul_u32_u24 v33, 21846, v32
  v_lshrrev_b32 v33, 16, v33
  v_mad_u32_u24 v32, v33, 9, v32
  v_lshlrev_b32 v32, 7, v32
  s_mul_i32 s6, s3, 384
  s_add_u32 s63, s63, s6
  s_mul_i32 s87, s65, 153600
  s_lshl_b32 s93, s3, 12
  s_mul_i32 s6, s3, 7680
  s_add_u32 s87, s87, s6
  s_add_u32 s87, s87, 16252928
  s_mul_i32 s92, s3, 5120
  s_min_u32 s5, s3, 2
  s_mul_i32 s6, s5, 5120
  s_mul_i32 s51, s67, 640
  s_add_u32 s51, s51, s6
  s_add_u32 s51, s51, 131072
  v_min_u32 v31, 39, v1
  v_lshlrev_b32 v34, 3, v31
  v_lshlrev_b32 v31, 4, v31
  s_mul_i32 s6, s5, 320
  s_add_u32 s6, s6, 153600
  s_cmp_eq_u32 s5, 2
  s_cselect_b32 s6, 162752, s6
  v_add_u32 v34, s6, v34
  s_cmp_eq_u32 s5, 1
  s_cselect_b32 s68, 1.0, 0
  s_mov_b32 s6, 153600
  v_lshl_add_u32 v35, v5, 5, s6
  v_lshl_add_u32 v36, v5, 4, s6
  v_lshlrev_b32 v37, 7, v5
  v_lshl_add_u32 v37, v6, 4, v37
  s_lshl_b32 s6, s64, 3
  s_sub_u32 s5, s6, 1
  s_max_i32 s5, s5, 0
  s_lshl_b32 s7, s3, 1
  s_add_u32 s6, s6, s7
  v_bfe_u32 v44, v1, 3, 1
  v_add_u32 v44, s6, v44
  v_mov_b32 v45, s5
  v_cmp_gt_u32 vcc, 16, v1
  s_nop 1
  v_cndmask_b32 v44, v45, v44, vcc
  v_lshrrev_b32 v45, 2, v44
  v_and_b32 v44, 3, v44
  v_lshl_add_u32 v44, v45, 5, v44
  v_min_u32 v45, 23, v1
  v_and_b32 v45, 7, v45
  v_lshl_add_u32 v44, v45, 2, v44
  v_lshlrev_b32 v44, 7, v44
  s_mov_b32 s78, 1900544
  s_mov_b64 s[40:41], s[26:27]
  s_mov_b32 s42, 2621440
  s_mov_b32 s43, 0x20000
  v_add_u32 v3, 0x10000, v2
  v_add_u32 v4, 0x20000, v2
  s_lshr_b32 s85, s2, 2
  s_lshl_b32 s90, s85, 7
  s_add_u32 s90, s90, s69
  s_mov_b64 s[52:53], s[24:25]
  s_mov_b32 s55, 0x20000
  s_sub_u32 s5, s2, 136
  s_cmpk_lt_u32 s5, 104
  s_cselect_b32 s84, 1, 0
  s_cselect_b32 s54, 4915200, 0
  v_mul_u32_u24 v188, 7680, v14
  v_add_u32 v188, v15, v188
  s_cmpk_ge_u32 s2, 120
  s_cselect_b32 s86, 1, 0
  s_cselect_b64 s[36:37], s[18:19], s[16:17]
  s_mul_i32 s5, s86, 120
  s_sub_u32 s5, s2, s5
  s_mul_i32 s82, s5, 10923
  s_lshr_b32 s82, s82, 16
  s_mul_i32 s6, s82, 6
  s_sub_u32 s83, s5, s6
  s_lshr_b32 s5, s82, 1
  s_mul_i32 s5, s5, 80
  s_and_b32 s6, s82, 1
  s_lshl_b32 s6, s6, 5
  s_add_u32 s5, s5, s6
  s_lshl_b32 s6, s3, 3
  s_add_u32 s5, s5, s6
  s_mul_i32 s6, s82, 160
  s_sub_u32 s6, s6, 2496
  s_lshr_b32 s7, s3, 1
  s_mul_i32 s7, s7, 80
  s_add_u32 s6, s6, s7
  s_and_b32 s7, s3, 1
  s_lshl_b32 s7, s7, 3
  s_add_u32 s6, s6, s7
  s_cmpk_lt_u32 s82, 16
  s_cselect_b32 s5, s5, s6
  s_mul_i32 s5, s5, 3072
  s_lshl_b32 s6, s83, 9
  s_add_u32 s61, s5, s6
  v_mul_u32_u24 v190, 3072, v14
  v_add_u32 v190, v15, v190
  s_lshl_b32 s5, s83, 3
  s_lshl_b32 s6, s3, 1
  s_add_u32 s5, s5, s6
  s_mul_i32 s5, s5, 20
  s_add_u32 s5, s5, s82
  s_lshl_b32 s5, s5, 12
  s_lshl_b32 s6, s86, 11
  s_add_u32 s5, s5, s6
  s_add_u32 s70, s5, 19922944
  s_lshl_b32 s5, s83, 2
  s_add_u32 s5, s5, s3
  s_lshl_b32 s5, s5, 6
  s_mul_i32 s6, s86, 20
  s_add_u32 s5, s5, s6
  s_add_u32 s5, s5, s82
  s_lshl_b32 s5, s5, 7
  s_add_u32 s71, s5, 1179648
  s_cmpk_ge_u32 s2, 240
  s_cselect_b32 s70, 117440512, s70
  s_cselect_b32 s71, 117440512, s71
  s_cselect_b32 s38, 0, 1966080
  v_mad_u32_u24 v181, v14, 34, v17
  v_lshlrev_b32 v181, 4, v181
  s_mul_i32 s5, s3, 4480
  s_add_u32 s5, s5, 104448
  v_add_u32 v181, s5, v181
  v_bfe_u32 v12, v1, 2, 2
  v_and_b32 v13, 3, v1
  v_mul_u32_u24 v185, 544, v12
  s_movk_i32 s5, 4480
  v_mad_u32_u24 v185, v5, s5, v185
  s_lshl_b32 s5, s3, 7
  s_add_u32 s5, s5, 104448
  v_add_u32 v185, s5, v185
  v_lshl_add_u32 v185, v13, 4, v185
  s_mul_i32 s62, s67, 640
  s_add_u32 s62, s62, 141312
  v_min_u32 v191, 39, v1
  v_lshlrev_b32 v191, 4, v191
  s_lshl_b32 s5, s64, 3
  s_lshl_b32 s6, s3, 1
  s_add_u32 s6, s6, s5
  s_mul_i32 s76, s6, 20480
  s_add_u32 s72, s76, 2097152
  s_add_u32 s73, s72, 20480
  s_sub_u32 s5, s5, 1
  s_max_i32 s5, s5, 0
  s_mul_i32 s74, s5, 20480
  s_add_u32 s74, s74, 2097152
  s_mul_i32 s5, s3, 3072
  s_add_u32 s75, s74, s5
  s_add_u32 s75, s75, 8192
  s_lshl_b32 s5, s3, 11
  s_add_u32 s74, s74, s5
  s_mul_i32 s81, s67, 102400
  s_add_u32 s82, s81, s92
  s_add_u32 s82, s82, 18956288
  s_lshl_b32 s5, s92, 2
  s_add_u32 s81, s81, s5
  s_add_u32 s81, s81, 18874368
  s_lshr_b32 s5, s67, 2
  s_lshl_b32 s5, s5, 6
  s_mul_i32 s6, s3, 12
  s_add_u32 s6, s6, s5
  v_min_u32 v186, 11, v1
  v_add_u32 v186, s6, v186
  v_lshlrev_b32 v186, 7, v186
  s_add_u32 s5, s5, 128
  s_lshl_b32 s6, s3, 2
  s_add_u32 s6, s6, s5
  v_add_u32 v182, s6, v1
  s_add_u32 s5, s5, 16
  s_add_u32 s5, s5, s3
  v_mov_b32 v12, s5
  v_cmp_gt_u32 vcc, 4, v1
  s_nop 1
  v_cndmask_b32 v182, v12, v182, vcc
  v_lshlrev_b32 v182, 7, v182
  s_mov_b32 s80, 851968
  s_cmp_lg_u32 s91, 117440512
  s_cbranch_scc1 QB_4
  s_waitcnt vmcnt(1)
  ds_write_b128 v53, v[88:91] offset:0
  ds_write_b128 v53, v[92:95] offset:128
  ds_write_b128 v53, v[96:99] offset:256
  ds_write_b128 v53, v[100:103] offset:384
  ds_write_b128 v53, v[104:107] offset:512
QB_4:
  s_add_u32 s6, s51, 0
  buffer_load_dwordx4 v[64:67], v31, s[32:35], s6 offen sc1
  s_add_u32 s6, s51, 30720
  buffer_load_dwordx4 v[68:71], v31, s[32:35], s6 offen sc1
  s_add_u32 s6, s51, 61440
  buffer_load_dwordx4 v[72:75], v31, s[32:35], s6 offen sc1
  s_add_u32 s6, s51, 92160
  buffer_load_dwordx4 v[76:79], v31, s[32:35], s6 offen sc1
  buffer_load_dwordx4 v[112:115], v2, s[32:35], s60 offen sc1
  buffer_load_dwordx4 v[116:119], v2, s[32:35], s60 offen offset:1024 sc1
  s_waitcnt vmcnt(2)
  s_movk_i32 s5, 0
TC_5:
  v_mov_b32 v24, 0
  v_xor_b32 v25, s4, v65
  v_xor_b32 v26, s4, v67
  v_or3_b32 v24, v24, v25, v26
  v_xor_b32 v25, s4, v69
  v_xor_b32 v26, s4, v71
  v_or3_b32 v24, v24, v25, v26
  v_xor_b32 v25, s4, v73
  v_xor_b32 v26, s4, v75
  v_or3_b32 v24, v24, v25, v26
  v_xor_b32 v25, s4, v77
  v_xor_b32 v26, s4, v79
  v_or3_b32 v24, v24, v25, v26
  v_cmp_ne_u32 vcc, 0, v24
  s_addk_i32 s5, 1
  s_cbranch_vccz TOK_6
  s_cmpk_ge_u32 s5, 20000
  s_cbranch_scc1 TOK_6
  s_sleep 2
  s_add_u32 s6, s51, 0
  buffer_load_dwordx4 v[64:67], v31, s[32:35], s6 offen sc1
  s_add_u32 s6, s51, 30720
  buffer_load_dwordx4 v[68:71], v31, s[32:35], s6 offen sc1
  s_add_u32 s6, s51, 61440
  buffer_load_dwordx4 v[72:75], v31, s[32:35], s6 offen sc1
  s_add_u32 s6, s51, 92160
  buffer_load_dwordx4 v[76:79], v31, s[32:35], s6 offen sc1
  s_waitcnt vmcnt(0)
  s_branch TC_5
TOK_6:
  v_add_f32 v64, v64, v68
  v_add_f32 v66, v66, v70
  v_add_f32 v72, v72, v76
  v_add_f32 v74, v74, v78
  v_add_f32 v64, v64, v72
  v_add_f32 v66, v66, v74
  v_cvt_pk_bf16_f32 v68, v64, v66
  v_lshlrev_b32 v64, 16, v68
  v_and_b32 v65, 0xffff0000, v68
  v_add_f32 v64, s68, v64
  v_add_f32 v65, s68, v65
  v_cvt_pk_bf16_f32 v68, v64, v65
  v_lshlrev_b32 v64, 16, v68
  v_and_b32 v65, 0xffff0000, v68
  ds_write_b64 v34, v[64:65]
  s_waitcnt vmcnt(0) lgkmcnt(0)
  s_barrier
  buffer_load_dword v33, v32, s[32:35], s63 offen sc1
  ds_read_b128 v[64:67], v35 offset:0
  ds_read_b128 v[68:71], v35 offset:16
  ds_read_b128 v[72:75], v35 offset:128
  ds_read_b128 v[76:79], v35 offset:144
  ds_read_b128 v[80:83], v36 offset:256
  ds_read_b128 v[84:87], v35 offset:320
  ds_read_b128 v[88:91], v35 offset:336
  ds_read_b128 v[92:95], v35 offset:448
  ds_read_b128 v[96:99], v35 offset:464
  ds_read_b128 v[100:103], v36 offset:576
  s_movk_i32 s5, 0
SG_9:
  s_addk_i32 s5, 1
  v_xor_b32 v24, s4, v113
  v_xor_b32 v25, s4, v115
  v_xor_b32 v26, s4, v117
  v_xor_b32 v27, s4, v119
  v_or3_b32 v24, v24, v25, v26
  v_or_b32 v24, v24, v27
  v_cmp_ne_u32 vcc, 0, v24
  s_cmpk_ge_u32 s5, 20000
  s_cbranch_scc1 SGX_10
  s_cbranch_vccz SGX_10
  buffer_load_dwordx4 v[112:115], v2, s[32:35], s60 offen sc1
  buffer_load_dwordx4 v[116:119], v2, s[32:35], s60 offen offset:1024 sc1
  s_waitcnt vmcnt(0)
  s_branch SG_9
SGX_10:
  v_add_f32 v22, v112, v116
  v_add_f32 v23, v114, v118
  v_mov_b32 v24, v22
  v_mov_b32 v25, v23
  s_nop 0
  v_permlane32_swap_b32 v22, v24
  v_permlane32_swap_b32 v23, v25
  v_add_f32 v22, v22, v24
  v_add_f32 v23, v23, v25
  v_mov_b32 v24, v22
  v_mov_b32 v25, v23
  s_nop 0
  v_permlane16_swap_b32 v22, v24
  v_permlane16_swap_b32 v23, v25
  v_add_f32 v22, v22, v24
  v_add_f32 v23, v23, v25
  v_mul_f32 v24, 0x3acccccd, v22
  v_mul_f32 v23, 0x3acccccd, v23
  v_fma_f32 v23, -v24, v24, v23
  v_max_f32 v23, 0, v23
  v_add_f32 v23, 0x3727c5ac, v23
  v_rsq_f32 v22, v23
  s_nop 0
  v_mul_f32_e64 v23, -v24, v22
  s_waitcnt lgkmcnt(0)
  v_pk_fma_f32 v[140:141], v[140:141], v[22:23], v[22:23] op_sel:[0,0,1] op_sel_hi:[1,0,1]
  v_pk_fma_f32 v[142:143], v[142:143], v[22:23], v[22:23] op_sel:[0,0,1] op_sel_hi:[1,0,1]
  v_pk_fma_f32 v[144:145], v[144:145], v[22:23], v[22:23] op_sel:[0,0,1] op_sel_hi:[1,0,1]
  v_pk_fma_f32 v[146:147], v[146:147], v[22:23], v[22:23] op_sel:[0,0,1] op_sel_hi:[1,0,1]
  v_pk_fma_f32 v[140:141], v[140:141], v[84:85], v[64:65]
  v_pk_fma_f32 v[142:143], v[142:143], v[86:87], v[66:67]
  v_pk_fma_f32 v[144:145], v[144:145], v[88:89], v[68:69]
  v_pk_fma_f32 v[146:147], v[146:147], v[90:91], v[70:71]
  v_cvt_pk_bf16_f32 v112, v140, v141
  v_cvt_pk_bf16_f32 v113, v142, v143
  v_cvt_pk_bf16_f32 v114, v144, v145
  v_cvt_pk_bf16_f32 v115, v146, v147
  buffer_store_dwordx4 v[112:115], v2, s[32:35], s58 offen offset:0 sc1
  v_pk_fma_f32 v[148:149], v[148:149], v[22:23], v[22:23] op_sel:[0,0,1] op_sel_hi:[1,0,1]
  v_pk_fma_f32 v[150:151], v[150:151], v[22:23], v[22:23] op_sel:[0,0,1] op_sel_hi:[1,0,1]
  v_pk_fma_f32 v[152:153], v[152:153], v[22:23], v[22:23] op_sel:[0,0,1] op_sel_hi:[1,0,1]
  v_pk_fma_f32 v[154:155], v[154:155], v[22:23], v[22:23] op_sel:[0,0,1] op_sel_hi:[1,0,1]
  v_pk_fma_f32 v[148:149], v[148:149], v[92:93], v[72:73]
  v_pk_fma_f32 v[150:151], v[150:151], v[94:95], v[74:75]
  v_pk_fma_f32 v[152:153], v[152:153], v[96:97], v[76:77]
  v_pk_fma_f32 v[154:155], v[154:155], v[98:99], v[78:79]
  v_cvt_pk_bf16_f32 v116, v148, v149
  v_cvt_pk_bf16_f32 v117, v150, v151
  v_cvt_pk_bf16_f32 v118, v152, v153
  v_cvt_pk_bf16_f32 v119, v154, v155
  buffer_store_dwordx4 v[116:119], v2, s[32:35], s58 offen offset:1024 sc1
  v_pk_fma_f32 v[156:157], v[156:157], v[22:23], v[22:23] op_sel:[0,0,1] op_sel_hi:[1,0,1]
  v_pk_fma_f32 v[158:159], v[158:159], v[22:23], v[22:23] op_sel:[0,0,1] op_sel_hi:[1,0,1]
  v_pk_fma_f32 v[156:157], v[156:157], v[100:101], v[80:81]
  v_pk_fma_f32 v[158:159], v[158:159], v[102:103], v[82:83]
  v_cvt_pk_bf16_f32 v120, v156, v157
  v_cvt_pk_bf16_f32 v121, v158, v159
  v_mov_b32 v122, v120
  v_mov_b32 v123, v121
  s_nop 0
  v_permlane16_swap_b32 v120, v122
  v_permlane16_swap_b32 v121, v123
  s_mov_b32 exec_lo, 0xffff
  s_mov_b32 exec_hi, 0xffff
  buffer_store_dwordx4 v[120:123], v37, s[32:35], s59 offen sc1
  s_mov_b64 exec, -1
  ds_read_b64_tr_b16 v[192:193], v56 offset:0
  ds_read_b64_tr_b16 v[194:195], v56 offset:2688
  ds_read_b64_tr_b16 v[196:197], v56 offset:8
  ds_read_b64_tr_b16 v[198:199], v56 offset:2696
  ds_read_b64_tr_b16 v[200:201], v56 offset:64
  ds_read_b64_tr_b16 v[202:203], v56 offset:2752
  ds_read_b64_tr_b16 v[204:205], v56 offset:72
  ds_read_b64_tr_b16 v[206:207], v56 offset:2760
  ds_read_b64_tr_b16 v[208:209], v57 offset:128
  ds_read_b64_tr_b16 v[210:211], v57 offset:2816
  s_mul_i32 s86, s3, 7680
  s_waitcnt vmcnt(3)
  v_cmp_ne_u32 vcc, s4, v33
  s_movk_i32 s91, 0
  s_cbranch_vccnz AE_7
  s_movk_i32 s91, 1
AE_7:
  s_cmp_eq_u32 s91, 1
  s_cbranch_scc1 AL_8
  s_waitcnt vmcnt(0)
  s_mov_b64 exec, 1
  buffer_store_dword v235, v2, s[32:35], s79 offen sc1
  s_mov_b64 exec, -1
  s_movk_i32 s5, 0
POLL_12:
  buffer_load_dword v33, v32, s[32:35], s63 offen sc1
  s_addk_i32 s5, 1
  s_waitcnt vmcnt(0)
  v_cmp_ne_u32 vcc, s4, v33
  s_cmpk_ge_u32 s5, 20000
  s_cbranch_scc1 POLLX_13
  s_cbranch_vccz POLLX_13
  s_mov_b64 exec, vcc
  s_sleep 8
  s_branch POLL_12
POLLX_13:
  s_mov_b64 exec, -1
  s_add_u32 m0, s86, 0
  s_add_u32 s7, s87, 0
  buffer_load_dwordx4 v2, s[32:35], s7 offen offset:0 sc1 lds
  buffer_load_dwordx4 v2, s[32:35], s7 offen offset:1024 sc1 lds
  buffer_load_dwordx4 v2, s[32:35], s7 offen offset:2048 sc1 lds
  buffer_load_dwordx4 v2, s[32:35], s7 offen offset:3072 sc1 lds
  s_add_u32 m0, s86, 4096
  s_add_u32 s7, s87, 4096
  buffer_load_dwordx4 v2, s[32:35], s7 offen offset:0 sc1 lds
  buffer_load_dwordx4 v2, s[32:35], s7 offen offset:1024 sc1 lds
  buffer_load_dwordx4 v2, s[32:35], s7 offen offset:2048 sc1 lds
  s_mov_b32 exec_hi, 0
  buffer_load_dwordx4 v2, s[32:35], s7 offen offset:3072 sc1 lds
  s_mov_b64 exec, -1
  s_branch HS_11
AL_8:
  s_add_u32 m0, s86, 0
  s_add_u32 s7, s87, 0
  buffer_load_dwordx4 v2, s[32:35], s7 offen offset:0 sc1 lds
  buffer_load_dwordx4 v2, s[32:35], s7 offen offset:1024 sc1 lds
  buffer_load_dwordx4 v2, s[32:35], s7 offen offset:2048 sc1 lds
  buffer_load_dwordx4 v2, s[32:35], s7 offen offset:3072 sc1 lds
  s_add_u32 m0, s86, 4096
  s_add_u32 s7, s87, 4096
  buffer_load_dwordx4 v2, s[32:35], s7 offen offset:0 sc1 lds
  buffer_load_dwordx4 v2, s[32:35], s7 offen offset:1024 sc1 lds
  buffer_load_dwordx4 v2, s[32:35], s7 offen offset:2048 sc1 lds
  s_mov_b32 exec_hi, 0
  buffer_load_dwordx4 v2, s[32:35], s7 offen offset:3072 sc1 lds
  s_mov_b64 exec, -1
  s_waitcnt vmcnt(8)
  s_mov_b64 exec, 1
  buffer_store_dword v235, v2, s[32:35], s79 offen sc1
  s_mov_b64 exec, -1
HS_11:
  s_waitcnt lgkmcnt(0)
  s_barrier
  s_cmp_eq_u32 s50, 117440512
  s_cbranch_scc1 NOWO_14
  s_add_u32 s6, s50, 4096
  buffer_store_dwordx4 v[192:195], v2, s[32:35], s50 offen offset:0 sc1
  buffer_store_dwordx4 v[196:199], v2, s[32:35], s50 offen offset:1024 sc1
  buffer_store_dwordx4 v[200:203], v2, s[32:35], s50 offen offset:2048 sc1
  buffer_store_dwordx4 v[204:207], v2, s[32:35], s50 offen offset:3072 sc1
  buffer_store_dwordx4 v[208:211], v2, s[32:35], s6 offen offset:0 sc1
NOWO_14:
  s_add_u32 m0, s86, 30720
  s_add_u32 s7, s87, 30720
  buffer_load_dwordx4 v2, s[32:35], s7 offen offset:0 sc1 lds
  buffer_load_dwordx4 v2, s[32:35], s7 offen offset:1024 sc1 lds
  buffer_load_dwordx4 v2, s[32:35], s7 offen offset:2048 sc1 lds
  buffer_load_dwordx4 v2, s[32:35], s7 offen offset:3072 sc1 lds
  v_and_b32 v12, 1, v1
  v_cmp_eq_u32 s[44:45], 1, v12
  v_lshl_add_u32 v13, v5, 2, v12
  v_cmp_le_u32 s[46:47], v13, v6
  v_add_u32 v13, 2, v13
  v_cmp_le_u32 s[56:57], v13, v6
  v_mov_b32 v12, 0xffff
  v_mov_b32 v13, 0xffff0000
  v_cndmask_b32 v12, v12, v13, s[44:45]
  v_cndmask_b32 v168, v12, 0, s[46:47]
  v_cndmask_b32 v169, v12, 0, s[56:57]
  s_add_u32 m0, s86, 34816
  s_add_u32 s7, s87, 34816
  buffer_load_dwordx4 v2, s[32:35], s7 offen offset:0 sc1 lds
  buffer_load_dwordx4 v2, s[32:35], s7 offen offset:1024 sc1 lds
  buffer_load_dwordx4 v2, s[32:35], s7 offen offset:2048 sc1 lds
  s_mov_b32 exec_hi, 0
  buffer_load_dwordx4 v2, s[32:35], s7 offen offset:3072 sc1 lds
  s_mov_b64 exec, -1
  v_cndmask_b32 v170, 0, v12, s[46:47]
  v_cndmask_b32 v171, 0, v12, s[56:57]
  v_cmp_eq_u32 vcc, 2, v5
  s_nop 1
  v_cndmask_b32 v172, 0, -1, vcc
  v_cmp_eq_u32 vcc, 3, v5
  s_nop 1
  v_cndmask_b32 v173, 0, -1, vcc
  s_or_b32 s5, s64, s3
  s_cmp_eq_u32 s5, 0
  s_cselect_b32 s5, 0xf149f2ca, 0
  v_mov_b32 v176, s5
  v_mov_b32 v177, s5
  v_mov_b32 v178, s5
  v_mov_b32 v179, s5
  s_add_u32 m0, s86, 61440
  s_add_u32 s7, s87, 61440
  buffer_load_dwordx4 v2, s[32:35], s7 offen offset:0 sc1 lds
  buffer_load_dwordx4 v2, s[32:35], s7 offen offset:1024 sc1 lds
  buffer_load_dwordx4 v2, s[32:35], s7 offen offset:2048 sc1 lds
  buffer_load_dword v45, v44, s[32:35], s78 offen sc1
  buffer_load_dwordx4 v2, s[32:35], s7 offen offset:3072 sc1 lds
  v_lshlrev_b32 v12, 3, v1
  s_mul_i32 s5, s3, 3072
  s_add_u32 s5, s5, 81920
  v_add_u32 v174, s5, v12
  s_lshl_b32 s5, s3, 9
  s_cmp_eq_u32 s3, 3
  s_cselect_b32 s5, 15360, s5
  s_add_u32 s5, s5, 81920
  v_add_u32 v175, s5, v12
  v_mul_u32_u24 v180, 20480, v5
  v_lshl_add_u32 v180, v6, 4, v180
  v_mov_b32 v8, v2
  v_lshl_add_u32 v9, v5, 7, v15
  s_add_u32 m0, s86, 65536
  s_add_u32 s7, s87, 65536
  buffer_load_dwordx4 v2, s[32:35], s7 offen offset:0 sc1 lds
  buffer_load_dwordx4 v2, s[32:35], s7 offen offset:1024 sc1 lds
  buffer_load_dwordx4 v2, s[32:35], s7 offen offset:2048 sc1 lds
  s_mov_b32 exec_hi, 0
  buffer_load_dwordx4 v2, s[32:35], s7 offen offset:3072 sc1 lds
  s_mov_b64 exec, -1
  v_and_b32 v13, 8, v1
  v_lshl_add_u32 v9, v13, 17, v9
  v_xor_b32 v13, 8, v13
  v_lshlrev_b32 v13, 17, v13
  s_min_u32 s5, s3, 2
  s_lshl_b32 s5, s5, 10
  v_add_u32 v10, s5, v2
  v_add_u32 v12, 2048, v9
  s_cmp_lt_u32 s3, 2
  s_cselect_b64 vcc, -1, 0
  v_cndmask_b32 v11, v12, v10, vcc
  v_cndmask_b32 v13, v13, 0, vcc
  v_add_u32 v10, v13, v10
  s_waitcnt vmcnt(5)
  v_cmp_ne_u32 vcc, s4, v45
  s_cbranch_vccz FOK_15
  s_mov_b64 exec, vcc
  s_movk_i32 s5, 0
POLL_16:
  buffer_load_dword v45, v44, s[32:35], s78 offen sc1
  s_addk_i32 s5, 1
  s_waitcnt vmcnt(0)
  v_cmp_ne_u32 vcc, s4, v45
  s_cmpk_ge_u32 s5, 20000
  s_cbranch_scc1 POLLX_17
  s_cbranch_vccz POLLX_17
  s_mov_b64 exec, vcc
  s_sleep 2
  s_branch POLL_16
POLLX_17:
  s_mov_b64 exec, -1
FOK_15:
  s_lshl_b32 s5, s3, 10
  s_sub_u32 s74, s74, s5
  buffer_load_dwordx4 a[0:3], v2, s[32:35], s72 offen offset:0 sc1
  buffer_load_dwordx4 a[4:7], v2, s[32:35], s73 offen offset:0 sc1
  buffer_load_dwordx4 a[232:235], v2, s[32:35], s74 offen sc1
  s_add_u32 s74, s74, 4096
  buffer_load_dwordx4 a[8:11], v2, s[32:35], s72 offen offset:1024 sc1
  buffer_load_dwordx4 a[12:15], v2, s[32:35], s73 offen offset:1024 sc1
  buffer_load_dwordx4 a[16:19], v2, s[32:35], s72 offen offset:2048 sc1
  buffer_load_dwordx4 a[20:23], v2, s[32:35], s73 offen offset:2048 sc1
  s_add_u32 s5, s3, 16
  s_mul_i32 s5, s5, 7680
  v_add_u32 v10, s5, v8
  v_add_u32 v11, s5, v9
  s_mul_i32 s5, s3, 6144
  v_add_u32 v12, s5, v8
  s_min_u32 s5, s3, 2
  s_lshl_b32 s5, s5, 10
  v_add_u32 v13, s5, v8
  s_waitcnt vmcnt(7)
  s_barrier
  ds_read_b128 v[88:91], v8 offset:0
  ds_read_b128 v[92:95], v8 offset:1024
  ds_read_b128 v[96:99], v8 offset:2048
  ds_read_b128 v[100:103], v8 offset:3072
  ds_read_b128 v[104:107], v8 offset:4096
  ds_read_b128 v[108:111], v8 offset:5120
  ds_read_b128 v[112:115], v8 offset:6144
  ds_read_b128 v[116:119], v9 offset:7168
  s_cmp_eq_u32 s3, 2
  s_cbranch_scc0 SIG_18
  s_mov_b64 exec, 1
  buffer_store_dword v235, v2, s[32:35], s95 offen sc1
  s_mov_b64 exec, -1
SIG_18:
  s_waitcnt vmcnt(4) lgkmcnt(0)
  v_mfma_f32_16x16x32_bf16 v[16:19], v[88:91], a[0:3], 0
  ds_read_b128 v[128:131], v8 offset:7680
  v_mfma_f32_16x16x32_bf16 v[48:51], v[88:91], a[4:7], 0
  ds_read_b128 v[132:135], v8 offset:8704
  v_mfma_f32_16x16x32_bf16 v[20:23], v[92:95], a[0:3], 0
  buffer_load_dwordx4 a[24:27], v2, s[32:35], s72 offen offset:3072 sc1
  s_add_u32 s72, s72, 4096
  v_mfma_f32_16x16x32_bf16 v[52:55], v[92:95], a[4:7], 0
  ds_read_b128 v[136:139], v8 offset:9728
  v_mfma_f32_16x16x32_bf16 v[24:27], v[96:99], a[0:3], 0
  ds_read_b128 v[140:143], v8 offset:10752
  v_mfma_f32_16x16x32_bf16 v[56:59], v[96:99], a[4:7], 0
  ds_read_b128 v[144:147], v8 offset:11776
  v_mfma_f32_16x16x32_bf16 v[28:31], v[100:103], a[0:3], 0
  buffer_load_dwordx4 a[28:31], v2, s[32:35], s73 offen offset:3072 sc1
  s_add_u32 s73, s73, 4096
  v_mfma_f32_16x16x32_bf16 v[60:63], v[100:103], a[4:7], 0
  ds_read_b128 v[148:151], v8 offset:12800
  v_mfma_f32_16x16x32_bf16 v[32:35], v[104:107], a[0:3], 0
  ds_read_b128 v[152:155], v8 offset:13824
  v_mfma_f32_16x16x32_bf16 v[64:67], v[104:107], a[4:7], 0
  ds_read_b128 v[156:159], v9 offset:14848
  v_mfma_f32_16x16x32_bf16 v[36:39], a[0:3], v[108:111], 0
  s_add_u32 m0, s86, 92160
  s_add_u32 s7, s87, 92160
  buffer_load_dwordx4 v2, s[32:35], s7 offen offset:0 sc1 lds
  v_mfma_f32_16x16x32_bf16 v[68:71], a[4:7], v[108:111], 0
  v_mfma_f32_16x16x32_bf16 v[40:43], a[0:3], v[112:115], 0
  v_mfma_f32_16x16x32_bf16 v[72:75], a[4:7], v[112:115], 0
  v_mfma_f32_16x16x32_bf16 v[44:47], a[0:3], v[116:119], 0
  s_add_u32 m0, s86, 92160
  s_add_u32 s7, s87, 92160
  buffer_load_dwordx4 v2, s[32:35], s7 offen offset:1024 sc1 lds
  v_mfma_f32_16x16x32_bf16 v[76:79], a[4:7], v[116:119], 0
  s_cmp_lg_u32 s3, 0
  s_cbranch_scc1 HK_19
  v_mfma_f32_16x16x32_bf16 v[80:83], v[96:99], a[232:235], 0
  v_mfma_f32_16x16x32_bf16 v[84:87], v[100:103], a[232:235], 0
  v_mfma_f32_16x16x32_bf16 v[120:123], v[104:107], a[232:235], 0
  v_mfma_f32_16x16x32_bf16 v[124:127], a[232:235], v[108:111], 0
  v_mfma_f32_16x16x32_bf16 v[160:163], a[232:235], v[112:115], 0
  v_mfma_f32_16x16x32_bf16 v[164:167], a[232:235], v[116:119], 0
HK_19:
  s_waitcnt vmcnt(6) lgkmcnt(0)
  v_mfma_f32_16x16x32_bf16 v[16:19], v[128:131], a[8:11], v[16:19]
  ds_read_b128 v[88:91], v8 offset:15360
  v_mfma_f32_16x16x32_bf16 v[48:51], v[128:131], a[12:15], v[48:51]
  ds_read_b128 v[92:95], v8 offset:16384
  v_mfma_f32_16x16x32_bf16 v[20:23], v[132:135], a[8:11], v[20:23]
  buffer_load_dwordx4 a[32:35], v2, s[32:35], s72 offen offset:0 sc1
  v_mfma_f32_16x16x32_bf16 v[52:55], v[132:135], a[12:15], v[52:55]
  ds_read_b128 v[96:99], v8 offset:17408
  v_mfma_f32_16x16x32_bf16 v[24:27], v[136:139], a[8:11], v[24:27]
  ds_read_b128 v[100:103], v8 offset:18432
  v_mfma_f32_16x16x32_bf16 v[56:59], v[136:139], a[12:15], v[56:59]
  ds_read_b128 v[104:107], v8 offset:19456
  v_mfma_f32_16x16x32_bf16 v[28:31], v[140:143], a[8:11], v[28:31]
  buffer_load_dwordx4 a[36:39], v2, s[32:35], s73 offen offset:0 sc1
  v_mfma_f32_16x16x32_bf16 v[60:63], v[140:143], a[12:15], v[60:63]
  ds_read_b128 v[108:111], v8 offset:20480
  v_mfma_f32_16x16x32_bf16 v[32:35], v[144:147], a[8:11], v[32:35]
  ds_read_b128 v[112:115], v8 offset:21504
  v_mfma_f32_16x16x32_bf16 v[64:67], v[144:147], a[12:15], v[64:67]
  ds_read_b128 v[116:119], v9 offset:22528
  v_mfma_f32_16x16x32_bf16 v[36:39], a[8:11], v[148:151], v[36:39]
  buffer_load_dwordx4 a[236:239], v2, s[32:35], s74 offen sc1
  s_add_u32 s74, s74, 4096
  v_mfma_f32_16x16x32_bf16 v[68:71], a[12:15], v[148:151], v[68:71]
  v_mfma_f32_16x16x32_bf16 v[40:43], a[8:11], v[152:155], v[40:43]
  v_mfma_f32_16x16x32_bf16 v[72:75], a[12:15], v[152:155], v[72:75]
  v_mfma_f32_16x16x32_bf16 v[44:47], a[8:11], v[156:159], v[44:47]
  s_add_u32 m0, s86, 92160
  s_add_u32 s7, s87, 92160
  buffer_load_dwordx4 v2, s[32:35], s7 offen offset:2048 sc1 lds
  v_mfma_f32_16x16x32_bf16 v[76:79], a[12:15], v[156:159], v[76:79]
  s_cmp_lg_u32 s3, 1
  s_cbranch_scc1 HK_20
  v_mfma_f32_16x16x32_bf16 v[80:83], v[136:139], a[232:235], 0
  v_mfma_f32_16x16x32_bf16 v[84:87], v[140:143], a[232:235], 0
  v_mfma_f32_16x16x32_bf16 v[120:123], v[144:147], a[232:235], 0
  v_mfma_f32_16x16x32_bf16 v[124:127], a[232:235], v[148:151], 0
  v_mfma_f32_16x16x32_bf16 v[160:163], a[232:235], v[152:155], 0
  v_mfma_f32_16x16x32_bf16 v[164:167], a[232:235], v[156:159], 0
HK_20:
  s_waitcnt vmcnt(8) lgkmcnt(0)
  v_mfma_f32_16x16x32_bf16 v[16:19], v[88:91], a[16:19], v[16:19]
  ds_read_b128 v[128:131], v8 offset:23040
  v_mfma_f32_16x16x32_bf16 v[48:51], v[88:91], a[20:23], v[48:51]
  ds_read_b128 v[132:135], v8 offset:24064
  v_mfma_f32_16x16x32_bf16 v[20:23], v[92:95], a[16:19], v[20:23]
  buffer_load_dwordx4 a[40:43], v2, s[32:35], s72 offen offset:1024 sc1
  v_mfma_f32_16x16x32_bf16 v[52:55], v[92:95], a[20:23], v[52:55]
  ds_read_b128 v[136:139], v8 offset:25088
  v_mfma_f32_16x16x32_bf16 v[24:27], v[96:99], a[16:19], v[24:27]
  ds_read_b128 v[140:143], v8 offset:26112
  v_mfma_f32_16x16x32_bf16 v[56:59], v[96:99], a[20:23], v[56:59]
  ds_read_b128 v[144:147], v8 offset:27136
  v_mfma_f32_16x16x32_bf16 v[28:31], v[100:103], a[16:19], v[28:31]
  buffer_load_dwordx4 a[44:47], v2, s[32:35], s73 offen offset:1024 sc1
  v_mfma_f32_16x16x32_bf16 v[60:63], v[100:103], a[20:23], v[60:63]
  ds_read_b128 v[148:151], v8 offset:28160
  v_mfma_f32_16x16x32_bf16 v[32:35], v[104:107], a[16:19], v[32:35]
  ds_read_b128 v[152:155], v8 offset:29184
  v_mfma_f32_16x16x32_bf16 v[64:67], v[104:107], a[20:23], v[64:67]
  ds_read_b128 v[156:159], v9 offset:30208
  v_mfma_f32_16x16x32_bf16 v[36:39], a[16:19], v[108:111], v[36:39]
  s_add_u32 m0, s86, 92160
  s_add_u32 s7, s87, 92160
  buffer_load_dwordx4 v2, s[32:35], s7 offen offset:3072 sc1 lds
  v_mfma_f32_16x16x32_bf16 v[68:71], a[20:23], v[108:111], v[68:71]
  v_mfma_f32_16x16x32_bf16 v[40:43], a[16:19], v[112:115], v[40:43]
  v_mfma_f32_16x16x32_bf16 v[72:75], a[20:23], v[112:115], v[72:75]
  v_mfma_f32_16x16x32_bf16 v[44:47], a[16:19], v[116:119], v[44:47]
  s_add_u32 m0, s86, 96256
  s_add_u32 s7, s87, 96256
  buffer_load_dwordx4 v2, s[32:35], s7 offen offset:0 sc1 lds
  v_mfma_f32_16x16x32_bf16 v[76:79], a[20:23], v[116:119], v[76:79]
  s_cmp_lg_u32 s3, 2
  s_cbranch_scc1 HK_21
  v_mfma_f32_16x16x32_bf16 v[80:83], v[96:99], a[232:235], 0
  v_mfma_f32_16x16x32_bf16 v[84:87], v[100:103], a[232:235], 0
  v_mfma_f32_16x16x32_bf16 v[120:123], v[104:107], a[232:235], 0
  v_mfma_f32_16x16x32_bf16 v[124:127], a[232:235], v[108:111], 0
  v_mfma_f32_16x16x32_bf16 v[160:163], a[232:235], v[112:115], 0
  v_mfma_f32_16x16x32_bf16 v[164:167], a[232:235], v[116:119], 0
HK_21:
  s_waitcnt vmcnt(10) lgkmcnt(0)
  v_mfma_f32_16x16x32_bf16 v[16:19], v[128:131], a[24:27], v[16:19]
  ds_read_b128 v[88:91], v8 offset:30720
  v_mfma_f32_16x16x32_bf16 v[48:51], v[128:131], a[28:31], v[48:51]
  ds_read_b128 v[92:95], v8 offset:31744
  v_mfma_f32_16x16x32_bf16 v[20:23], v[132:135], a[24:27], v[20:23]
  buffer_store_dwordx4 v[192:195], v2, s[32:35], s48 offen offset:0 sc1
  v_mfma_f32_16x16x32_bf16 v[52:55], v[132:135], a[28:31], v[52:55]
  ds_read_b128 v[96:99], v8 offset:32768
  v_mfma_f32_16x16x32_bf16 v[24:27], v[136:139], a[24:27], v[24:27]
  ds_read_b128 v[100:103], v8 offset:33792
  v_mfma_f32_16x16x32_bf16 v[56:59], v[136:139], a[28:31], v[56:59]
  buffer_load_dwordx4 a[48:51], v2, s[32:35], s72 offen offset:2048 sc1
  v_mfma_f32_16x16x32_bf16 v[28:31], v[140:143], a[24:27], v[28:31]
  ds_read_b128 v[104:107], v8 offset:34816
  v_mfma_f32_16x16x32_bf16 v[60:63], v[140:143], a[28:31], v[60:63]
  ds_read_b128 v[108:111], v8 offset:35840
  v_mfma_f32_16x16x32_bf16 v[32:35], v[144:147], a[24:27], v[32:35]
  buffer_load_dwordx4 a[52:55], v2, s[32:35], s73 offen offset:2048 sc1
  v_mfma_f32_16x16x32_bf16 v[64:67], v[144:147], a[28:31], v[64:67]
  ds_read_b128 v[112:115], v8 offset:36864
  v_mfma_f32_16x16x32_bf16 v[36:39], a[24:27], v[148:151], v[36:39]
  ds_read_b128 v[116:119], v9 offset:37888
  v_mfma_f32_16x16x32_bf16 v[68:71], a[28:31], v[148:151], v[68:71]
  s_add_u32 m0, s86, 96256
  s_add_u32 s7, s87, 96256
  buffer_load_dwordx4 v2, s[32:35], s7 offen offset:1024 sc1 lds
  v_mfma_f32_16x16x32_bf16 v[40:43], a[24:27], v[152:155], v[40:43]
  v_mfma_f32_16x16x32_bf16 v[72:75], a[28:31], v[152:155], v[72:75]
  v_mfma_f32_16x16x32_bf16 v[44:47], a[24:27], v[156:159], v[44:47]
  s_add_u32 m0, s86, 96256
  s_add_u32 s7, s87, 96256
  buffer_load_dwordx4 v2, s[32:35], s7 offen offset:2048 sc1 lds
  v_mfma_f32_16x16x32_bf16 v[76:79], a[28:31], v[156:159], v[76:79]
  s_cmp_lg_u32 s3, 3
  s_cbranch_scc1 HK_22
  v_mfma_f32_16x16x32_bf16 v[80:83], v[136:139], a[232:235], 0
  v_mfma_f32_16x16x32_bf16 v[84:87], v[140:143], a[232:235], 0
  v_mfma_f32_16x16x32_bf16 v[120:123], v[144:147], a[232:235], 0
  v_mfma_f32_16x16x32_bf16 v[124:127], a[232:235], v[148:151], 0
  v_mfma_f32_16x16x32_bf16 v[160:163], a[232:235], v[152:155], 0
  v_mfma_f32_16x16x32_bf16 v[164:167], a[232:235], v[156:159], 0
HK_22:
  s_waitcnt vmcnt(10) lgkmcnt(0)
  v_mfma_f32_16x16x32_bf16 v[16:19], v[88:91], a[32:35], v[16:19]
  ds_read_b128 v[128:131], v8 offset:38400
  v_mfma_f32_16x16x32_bf16 v[48:51], v[88:91], a[36:39], v[48:51]
  ds_read_b128 v[132:135], v8 offset:39424
  v_mfma_f32_16x16x32_bf16 v[20:23], v[92:95], a[32:35], v[20:23]
  buffer_store_dwordx4 v[196:199], v2, s[32:35], s48 offen offset:1024 sc1
  v_mfma_f32_16x16x32_bf16 v[52:55], v[92:95], a[36:39], v[52:55]
  ds_read_b128 v[136:139], v8 offset:40448
  v_mfma_f32_16x16x32_bf16 v[24:27], v[96:99], a[32:35], v[24:27]
  ds_read_b128 v[140:143], v8 offset:41472
  v_mfma_f32_16x16x32_bf16 v[56:59], v[96:99], a[36:39], v[56:59]
  buffer_load_dwordx4 a[56:59], v2, s[32:35], s72 offen offset:3072 sc1
  s_add_u32 s72, s72, 4096
  v_mfma_f32_16x16x32_bf16 v[28:31], v[100:103], a[32:35], v[28:31]
  ds_read_b128 v[144:147], v8 offset:42496
  v_mfma_f32_16x16x32_bf16 v[60:63], v[100:103], a[36:39], v[60:63]
  ds_read_b128 v[148:151], v8 offset:43520
  v_mfma_f32_16x16x32_bf16 v[32:35], v[104:107], a[32:35], v[32:35]
  buffer_load_dwordx4 a[60:63], v2, s[32:35], s73 offen offset:3072 sc1
  s_add_u32 s73, s73, 4096
  v_mfma_f32_16x16x32_bf16 v[64:67], v[104:107], a[36:39], v[64:67]
  ds_read_b128 v[152:155], v8 offset:44544
  v_mfma_f32_16x16x32_bf16 v[36:39], a[32:35], v[108:111], v[36:39]
  ds_read_b128 v[156:159], v9 offset:45568
  v_mfma_f32_16x16x32_bf16 v[68:71], a[36:39], v[108:111], v[68:71]
  s_add_u32 m0, s86, 96256
  s_add_u32 s7, s87, 96256
  s_mov_b32 exec_hi, 0
  buffer_load_dwordx4 v2, s[32:35], s7 offen offset:3072 sc1 lds
  s_mov_b64 exec, -1
  v_mfma_f32_16x16x32_bf16 v[40:43], a[32:35], v[112:115], v[40:43]
  v_mfma_f32_16x16x32_bf16 v[72:75], a[36:39], v[112:115], v[72:75]
  v_mfma_f32_16x16x32_bf16 v[44:47], a[32:35], v[116:119], v[44:47]
  s_add_u32 m0, s86, 122880
  s_add_u32 s7, s87, 122880
  buffer_load_dwordx4 v2, s[32:35], s7 offen offset:0 sc1 lds
  v_mfma_f32_16x16x32_bf16 v[76:79], a[36:39], v[116:119], v[76:79]
  s_cmp_lg_u32 s3, 0
  s_cbranch_scc1 HK_23
  v_mfma_f32_16x16x32_bf16 v[80:83], v[96:99], a[236:239], v[80:83]
  v_mfma_f32_16x16x32_bf16 v[84:87], v[100:103], a[236:239], v[84:87]
  v_mfma_f32_16x16x32_bf16 v[120:123], v[104:107], a[236:239], v[120:123]
  v_mfma_f32_16x16x32_bf16 v[124:127], a[236:239], v[108:111], v[124:127]
  v_mfma_f32_16x16x32_bf16 v[160:163], a[236:239], v[112:115], v[160:163]
  v_mfma_f32_16x16x32_bf16 v[164:167], a[236:239], v[116:119], v[164:167]
HK_23:
  s_waitcnt vmcnt(12) lgkmcnt(0)
  v_mfma_f32_16x16x32_bf16 v[16:19], v[128:131], a[40:43], v[16:19]
  ds_read_b128 v[88:91], v8 offset:46080
  v_mfma_f32_16x16x32_bf16 v[48:51], v[128:131], a[44:47], v[48:51]
  ds_read_b128 v[92:95], v8 offset:47104
  v_mfma_f32_16x16x32_bf16 v[20:23], v[132:135], a[40:43], v[20:23]
  buffer_store_dwordx4 v[200:203], v2, s[32:35], s48 offen offset:2048 sc1
  v_mfma_f32_16x16x32_bf16 v[52:55], v[132:135], a[44:47], v[52:55]
  ds_read_b128 v[96:99], v8 offset:48128
  v_mfma_f32_16x16x32_bf16 v[24:27], v[136:139], a[40:43], v[24:27]
  ds_read_b128 v[100:103], v8 offset:49152
  v_mfma_f32_16x16x32_bf16 v[56:59], v[136:139], a[44:47], v[56:59]
  buffer_load_dwordx4 a[64:67], v2, s[32:35], s72 offen offset:0 sc1
  v_mfma_f32_16x16x32_bf16 v[28:31], v[140:143], a[40:43], v[28:31]
  ds_read_b128 v[104:107], v8 offset:50176
  v_mfma_f32_16x16x32_bf16 v[60:63], v[140:143], a[44:47], v[60:63]
  ds_read_b128 v[108:111], v8 offset:51200
  v_mfma_f32_16x16x32_bf16 v[32:35], v[144:147], a[40:43], v[32:35]
  buffer_load_dwordx4 a[68:71], v2, s[32:35], s73 offen offset:0 sc1
  v_mfma_f32_16x16x32_bf16 v[64:67], v[144:147], a[44:47], v[64:67]
  ds_read_b128 v[112:115], v8 offset:52224
  v_mfma_f32_16x16x32_bf16 v[36:39], a[40:43], v[148:151], v[36:39]
  ds_read_b128 v[116:119], v9 offset:53248
  v_mfma_f32_16x16x32_bf16 v[68:71], a[44:47], v[148:151], v[68:71]
  buffer_load_dwordx4 a[250:253], v2, s[32:35], s74 offen sc1
  s_add_u32 s74, s74, 4096
  v_mfma_f32_16x16x32_bf16 v[40:43], a[40:43], v[152:155], v[40:43]
  v_mfma_f32_16x16x32_bf16 v[72:75], a[44:47], v[152:155], v[72:75]
  v_mfma_f32_16x16x32_bf16 v[44:47], a[40:43], v[156:159], v[44:47]
  s_add_u32 m0, s86, 122880
  s_add_u32 s7, s87, 122880
  buffer_load_dwordx4 v2, s[32:35], s7 offen offset:1024 sc1 lds
  v_mfma_f32_16x16x32_bf16 v[76:79], a[44:47], v[156:159], v[76:79]
  s_cmp_lg_u32 s3, 1
  s_cbranch_scc1 HK_24
  v_mfma_f32_16x16x32_bf16 v[80:83], v[136:139], a[236:239], v[80:83]
  v_mfma_f32_16x16x32_bf16 v[84:87], v[140:143], a[236:239], v[84:87]
  v_mfma_f32_16x16x32_bf16 v[120:123], v[144:147], a[236:239], v[120:123]
  v_mfma_f32_16x16x32_bf16 v[124:127], a[236:239], v[148:151], v[124:127]
  v_mfma_f32_16x16x32_bf16 v[160:163], a[236:239], v[152:155], v[160:163]
  v_mfma_f32_16x16x32_bf16 v[164:167], a[236:239], v[156:159], v[164:167]
HK_24:
  s_waitcnt vmcnt(12) lgkmcnt(0)
  v_mfma_f32_16x16x32_bf16 v[16:19], v[88:91], a[48:51], v[16:19]
  ds_read_b128 v[128:131], v8 offset:53760
  v_mfma_f32_16x16x32_bf16 v[48:51], v[88:91], a[52:55], v[48:51]
  ds_read_b128 v[132:135], v8 offset:54784
  v_mfma_f32_16x16x32_bf16 v[20:23], v[92:95], a[48:51], v[20:23]
  buffer_store_dwordx4 v[204:207], v2, s[32:35], s48 offen offset:3072 sc1
  v_mfma_f32_16x16x32_bf16 v[52:55], v[92:95], a[52:55], v[52:55]
  ds_read_b128 v[136:139], v8 offset:55808
  v_mfma_f32_16x16x32_bf16 v[24:27], v[96:99], a[48:51], v[24:27]
  ds_read_b128 v[140:143], v8 offset:56832
  v_mfma_f32_16x16x32_bf16 v[56:59], v[96:99], a[52:55], v[56:59]
  buffer_load_dwordx4 a[72:75], v2, s[32:35], s72 offen offset:1024 sc1
  v_mfma_f32_16x16x32_bf16 v[28:31], v[100:103], a[48:51], v[28:31]
  ds_read_b128 v[144:147], v8 offset:57856
  v_mfma_f32_16x16x32_bf16 v[60:63], v[100:103], a[52:55], v[60:63]
  ds_read_b128 v[148:151], v8 offset:58880
  v_mfma_f32_16x16x32_bf16 v[32:35], v[104:107], a[48:51], v[32:35]
  buffer_load_dwordx4 a[76:79], v2, s[32:35], s73 offen offset:1024 sc1
  v_mfma_f32_16x16x32_bf16 v[64:67], v[104:107], a[52:55], v[64:67]
  ds_read_b128 v[152:155], v8 offset:59904
  v_mfma_f32_16x16x32_bf16 v[36:39], a[48:51], v[108:111], v[36:39]
  ds_read_b128 v[156:159], v9 offset:60928
  v_mfma_f32_16x16x32_bf16 v[68:71], a[52:55], v[108:111], v[68:71]
  s_add_u32 m0, s86, 122880
  s_add_u32 s7, s87, 122880
  buffer_load_dwordx4 v2, s[32:35], s7 offen offset:2048 sc1 lds
  v_mfma_f32_16x16x32_bf16 v[40:43], a[48:51], v[112:115], v[40:43]
  v_mfma_f32_16x16x32_bf16 v[72:75], a[52:55], v[112:115], v[72:75]
  v_mfma_f32_16x16x32_bf16 v[44:47], a[48:51], v[116:119], v[44:47]
  s_add_u32 m0, s86, 122880
  s_add_u32 s7, s87, 122880
  buffer_load_dwordx4 v2, s[32:35], s7 offen offset:3072 sc1 lds
  v_mfma_f32_16x16x32_bf16 v[76:79], a[52:55], v[116:119], v[76:79]
  s_cmp_lg_u32 s3, 2
  s_cbranch_scc1 HK_25
  v_mfma_f32_16x16x32_bf16 v[80:83], v[96:99], a[236:239], v[80:83]
  v_mfma_f32_16x16x32_bf16 v[84:87], v[100:103], a[236:239], v[84:87]
  v_mfma_f32_16x16x32_bf16 v[120:123], v[104:107], a[236:239], v[120:123]
  v_mfma_f32_16x16x32_bf16 v[124:127], a[236:239], v[108:111], v[124:127]
  v_mfma_f32_16x16x32_bf16 v[160:163], a[236:239], v[112:115], v[160:163]
  v_mfma_f32_16x16x32_bf16 v[164:167], a[236:239], v[116:119], v[164:167]
HK_25:
  s_waitcnt vmcnt(12) lgkmcnt(0)
  v_mfma_f32_16x16x32_bf16 v[16:19], v[128:131], a[56:59], v[16:19]
  v_add_u32 v8, 61440, v8
  v_add_u32 v9, 61440, v9
  v_mfma_f32_16x16x32_bf16 v[48:51], v[128:131], a[60:63], v[48:51]
  ds_read_b128 v[88:91], v8 offset:0
  v_mfma_f32_16x16x32_bf16 v[20:23], v[132:135], a[56:59], v[20:23]
  buffer_store_dwordx4 v[208:211], v2, s[32:35], s49 offen offset:0 sc1
  v_mfma_f32_16x16x32_bf16 v[52:55], v[132:135], a[60:63], v[52:55]
  ds_read_b128 v[92:95], v8 offset:1024
  v_mfma_f32_16x16x32_bf16 v[24:27], v[136:139], a[56:59], v[24:27]
  ds_read_b128 v[96:99], v8 offset:2048
  v_mfma_f32_16x16x32_bf16 v[56:59], v[136:139], a[60:63], v[56:59]
  buffer_load_dwordx4 a[80:83], v2, s[32:35], s72 offen offset:2048 sc1
  v_mfma_f32_16x16x32_bf16 v[28:31], v[140:143], a[56:59], v[28:31]
  ds_read_b128 v[100:103], v8 offset:3072
  v_mfma_f32_16x16x32_bf16 v[60:63], v[140:143], a[60:63], v[60:63]
  ds_read_b128 v[104:107], v8 offset:4096
  v_mfma_f32_16x16x32_bf16 v[32:35], v[144:147], a[56:59], v[32:35]
  buffer_load_dwordx4 a[84:87], v2, s[32:35], s73 offen offset:2048 sc1
  v_mfma_f32_16x16x32_bf16 v[64:67], v[144:147], a[60:63], v[64:67]
  ds_read_b128 v[108:111], v8 offset:5120
  v_mfma_f32_16x16x32_bf16 v[36:39], a[56:59], v[148:151], v[36:39]
  ds_read_b128 v[112:115], v8 offset:6144
  v_mfma_f32_16x16x32_bf16 v[68:71], a[60:63], v[148:151], v[68:71]
  s_add_u32 m0, s86, 126976
  s_add_u32 s7, s87, 126976
  buffer_load_dwordx4 v2, s[32:35], s7 offen offset:0 sc1 lds
  v_mfma_f32_16x16x32_bf16 v[40:43], a[56:59], v[152:155], v[40:43]
  ds_read_b128 v[116:119], v9 offset:7168
  v_mfma_f32_16x16x32_bf16 v[72:75], a[60:63], v[152:155], v[72:75]
  v_mfma_f32_16x16x32_bf16 v[44:47], a[56:59], v[156:159], v[44:47]
  s_add_u32 m0, s86, 126976
  s_add_u32 s7, s87, 126976
  buffer_load_dwordx4 v2, s[32:35], s7 offen offset:1024 sc1 lds
  v_mfma_f32_16x16x32_bf16 v[76:79], a[60:63], v[156:159], v[76:79]
  s_cmp_lg_u32 s3, 3
  s_cbranch_scc1 HK_26
  v_mfma_f32_16x16x32_bf16 v[80:83], v[136:139], a[236:239], v[80:83]
  v_mfma_f32_16x16x32_bf16 v[84:87], v[140:143], a[236:239], v[84:87]
  v_mfma_f32_16x16x32_bf16 v[120:123], v[144:147], a[236:239], v[120:123]
  v_mfma_f32_16x16x32_bf16 v[124:127], a[236:239], v[148:151], v[124:127]
  v_mfma_f32_16x16x32_bf16 v[160:163], a[236:239], v[152:155], v[160:163]
  v_mfma_f32_16x16x32_bf16 v[164:167], a[236:239], v[156:159], v[164:167]
HK_26:
  s_waitcnt vmcnt(11) lgkmcnt(0)
  v_mfma_f32_16x16x32_bf16 v[16:19], v[88:91], a[64:67], v[16:19]
  ds_read_b128 v[128:131], v8 offset:7680
  v_mfma_f32_16x16x32_bf16 v[48:51], v[88:91], a[68:71], v[48:51]
  ds_read_b128 v[132:135], v8 offset:8704
  v_mfma_f32_16x16x32_bf16 v[20:23], v[92:95], a[64:67], v[20:23]
  buffer_load_dwordx4 a[0:3], v2, s[32:35], s72 offen offset:3072 sc1
  s_add_u32 s72, s72, 4096
  v_mfma_f32_16x16x32_bf16 v[52:55], v[92:95], a[68:71], v[52:55]
  ds_read_b128 v[136:139], v8 offset:9728
  v_mfma_f32_16x16x32_bf16 v[24:27], v[96:99], a[64:67], v[24:27]
  ds_read_b128 v[140:143], v8 offset:10752
  v_mfma_f32_16x16x32_bf16 v[56:59], v[96:99], a[68:71], v[56:59]
  ds_read_b128 v[144:147], v8 offset:11776
  v_mfma_f32_16x16x32_bf16 v[28:31], v[100:103], a[64:67], v[28:31]
  buffer_load_dwordx4 a[4:7], v2, s[32:35], s73 offen offset:3072 sc1
  s_add_u32 s73, s73, 4096
  v_mfma_f32_16x16x32_bf16 v[60:63], v[100:103], a[68:71], v[60:63]
  ds_read_b128 v[148:151], v8 offset:12800
  v_mfma_f32_16x16x32_bf16 v[32:35], v[104:107], a[64:67], v[32:35]
  ds_read_b128 v[152:155], v8 offset:13824
  v_mfma_f32_16x16x32_bf16 v[64:67], v[104:107], a[68:71], v[64:67]
  ds_read_b128 v[156:159], v9 offset:14848
  v_mfma_f32_16x16x32_bf16 v[36:39], a[64:67], v[108:111], v[36:39]
  s_add_u32 m0, s86, 126976
  s_add_u32 s7, s87, 126976
  buffer_load_dwordx4 v2, s[32:35], s7 offen offset:2048 sc1 lds
  v_mfma_f32_16x16x32_bf16 v[68:71], a[68:71], v[108:111], v[68:71]
  v_mfma_f32_16x16x32_bf16 v[40:43], a[64:67], v[112:115], v[40:43]
  v_mfma_f32_16x16x32_bf16 v[72:75], a[68:71], v[112:115], v[72:75]
  v_mfma_f32_16x16x32_bf16 v[44:47], a[64:67], v[116:119], v[44:47]
  s_add_u32 m0, s86, 126976
  s_add_u32 s7, s87, 126976
  s_mov_b32 exec_hi, 0
  buffer_load_dwordx4 v2, s[32:35], s7 offen offset:3072 sc1 lds
  s_mov_b64 exec, -1
  v_mfma_f32_16x16x32_bf16 v[76:79], a[68:71], v[116:119], v[76:79]
  s_cmp_lg_u32 s3, 0
  s_cbranch_scc1 HK_27
  v_mfma_f32_16x16x32_bf16 v[80:83], v[96:99], a[250:253], v[80:83]
  v_mfma_f32_16x16x32_bf16 v[84:87], v[100:103], a[250:253], v[84:87]
  v_mfma_f32_16x16x32_bf16 v[120:123], v[104:107], a[250:253], v[120:123]
  v_mfma_f32_16x16x32_bf16 v[124:127], a[250:253], v[108:111], v[124:127]
  v_mfma_f32_16x16x32_bf16 v[160:163], a[250:253], v[112:115], v[160:163]
  v_mfma_f32_16x16x32_bf16 v[164:167], a[250:253], v[116:119], v[164:167]
HK_27:
  s_waitcnt vmcnt(11) lgkmcnt(0)
  v_mfma_f32_16x16x32_bf16 v[16:19], v[128:131], a[72:75], v[16:19]
  ds_read_b128 v[88:91], v8 offset:15360
  v_mfma_f32_16x16x32_bf16 v[48:51], v[128:131], a[76:79], v[48:51]
  ds_read_b128 v[92:95], v8 offset:16384
  v_mfma_f32_16x16x32_bf16 v[20:23], v[132:135], a[72:75], v[20:23]
  buffer_load_dwordx4 a[8:11], v2, s[32:35], s72 offen offset:0 sc1
  v_mfma_f32_16x16x32_bf16 v[52:55], v[132:135], a[76:79], v[52:55]
  ds_read_b128 v[96:99], v8 offset:17408
  v_mfma_f32_16x16x32_bf16 v[24:27], v[136:139], a[72:75], v[24:27]
  ds_read_b128 v[100:103], v8 offset:18432
  v_mfma_f32_16x16x32_bf16 v[56:59], v[136:139], a[76:79], v[56:59]
  ds_read_b128 v[104:107], v8 offset:19456
  v_mfma_f32_16x16x32_bf16 v[28:31], v[140:143], a[72:75], v[28:31]
  buffer_load_dwordx4 a[12:15], v2, s[32:35], s73 offen offset:0 sc1
  v_mfma_f32_16x16x32_bf16 v[60:63], v[140:143], a[76:79], v[60:63]
  ds_read_b128 v[108:111], v8 offset:20480
  v_mfma_f32_16x16x32_bf16 v[32:35], v[144:147], a[72:75], v[32:35]
  ds_read_b128 v[112:115], v8 offset:21504
  v_mfma_f32_16x16x32_bf16 v[64:67], v[144:147], a[76:79], v[64:67]
  ds_read_b128 v[116:119], v9 offset:22528
  v_mfma_f32_16x16x32_bf16 v[36:39], a[72:75], v[148:151], v[36:39]
  buffer_load_dwordx4 a[88:91], v2, s[32:35], s74 offen sc1
  s_add_u32 s74, s74, 4096
  v_mfma_f32_16x16x32_bf16 v[68:71], a[76:79], v[148:151], v[68:71]
  v_mfma_f32_16x16x32_bf16 v[40:43], a[72:75], v[152:155], v[40:43]
  v_mfma_f32_16x16x32_bf16 v[72:75], a[76:79], v[152:155], v[72:75]
  v_mfma_f32_16x16x32_bf16 v[44:47], a[72:75], v[156:159], v[44:47]
  buffer_load_dwordx4 a[16:19], v2, s[32:35], s72 offen offset:1024 sc1
  v_mfma_f32_16x16x32_bf16 v[76:79], a[76:79], v[156:159], v[76:79]
  s_cmp_lg_u32 s3, 1
  s_cbranch_scc1 HK_28
  v_mfma_f32_16x16x32_bf16 v[80:83], v[136:139], a[250:253], v[80:83]
  v_mfma_f32_16x16x32_bf16 v[84:87], v[140:143], a[250:253], v[84:87]
  v_mfma_f32_16x16x32_bf16 v[120:123], v[144:147], a[250:253], v[120:123]
  v_mfma_f32_16x16x32_bf16 v[124:127], a[250:253], v[148:151], v[124:127]
  v_mfma_f32_16x16x32_bf16 v[160:163], a[250:253], v[152:155], v[160:163]
  v_mfma_f32_16x16x32_bf16 v[164:167], a[250:253], v[156:159], v[164:167]
HK_28:
  s_waitcnt vmcnt(10) lgkmcnt(0)
  v_mfma_f32_16x16x32_bf16 v[16:19], v[88:91], a[80:83], v[16:19]
  ds_read_b128 v[128:131], v8 offset:23040
  v_mfma_f32_16x16x32_bf16 v[48:51], v[88:91], a[84:87], v[48:51]
  ds_read_b128 v[132:135], v8 offset:24064
  v_mfma_f32_16x16x32_bf16 v[20:23], v[92:95], a[80:83], v[20:23]
  buffer_load_dwordx4 a[20:23], v2, s[32:35], s73 offen offset:1024 sc1
  v_mfma_f32_16x16x32_bf16 v[52:55], v[92:95], a[84:87], v[52:55]
  ds_read_b128 v[136:139], v8 offset:25088
  v_mfma_f32_16x16x32_bf16 v[24:27], v[96:99], a[80:83], v[24:27]
  ds_read_b128 v[140:143], v8 offset:26112
  v_mfma_f32_16x16x32_bf16 v[56:59], v[96:99], a[84:87], v[56:59]
  ds_read_b128 v[144:147], v8 offset:27136
  v_mfma_f32_16x16x32_bf16 v[28:31], v[100:103], a[80:83], v[28:31]
  buffer_load_dwordx4 a[24:27], v2, s[32:35], s72 offen offset:2048 sc1
  v_mfma_f32_16x16x32_bf16 v[60:63], v[100:103], a[84:87], v[60:63]
  ds_read_b128 v[148:151], v8 offset:28160
  v_mfma_f32_16x16x32_bf16 v[32:35], v[104:107], a[80:83], v[32:35]
  ds_read_b128 v[152:155], v8 offset:29184
  v_mfma_f32_16x16x32_bf16 v[64:67], v[104:107], a[84:87], v[64:67]
  ds_read_b128 v[156:159], v9 offset:30208
  v_mfma_f32_16x16x32_bf16 v[36:39], a[80:83], v[108:111], v[36:39]
  buffer_load_dwordx4 a[28:31], v2, s[32:35], s73 offen offset:2048 sc1
  v_mfma_f32_16x16x32_bf16 v[68:71], a[84:87], v[108:111], v[68:71]
  v_mfma_f32_16x16x32_bf16 v[40:43], a[80:83], v[112:115], v[40:43]
  v_mfma_f32_16x16x32_bf16 v[72:75], a[84:87], v[112:115], v[72:75]
  v_mfma_f32_16x16x32_bf16 v[44:47], a[80:83], v[116:119], v[44:47]
  buffer_load_dwordx4 a[92:95], v2, s[32:35], s74 offen sc1
  s_add_u32 s74, s74, 4096
  v_mfma_f32_16x16x32_bf16 v[76:79], a[84:87], v[116:119], v[76:79]
  s_cmp_lg_u32 s3, 2
  s_cbranch_scc1 HK_29
  v_mfma_f32_16x16x32_bf16 v[80:83], v[96:99], a[250:253], v[80:83]
  v_mfma_f32_16x16x32_bf16 v[84:87], v[100:103], a[250:253], v[84:87]
  v_mfma_f32_16x16x32_bf16 v[120:123], v[104:107], a[250:253], v[120:123]
  v_mfma_f32_16x16x32_bf16 v[124:127], a[250:253], v[108:111], v[124:127]
  v_mfma_f32_16x16x32_bf16 v[160:163], a[250:253], v[112:115], v[160:163]
  v_mfma_f32_16x16x32_bf16 v[164:167], a[250:253], v[116:119], v[164:167]
HK_29:
  s_waitcnt vmcnt(10) lgkmcnt(0)
  s_waitcnt vmcnt(8)
  s_barrier
  s_cmp_eq_u32 s3, 2
  s_cbranch_scc0 SIG_30
  s_mov_b64 exec, 1
  buffer_store_dword v235, v2, s[32:35], s94 offen sc1
  s_mov_b64 exec, -1
SIG_30:
  v_mfma_f32_16x16x32_bf16 v[16:19], v[128:131], a[0:3], v[16:19]
  ds_read_b128 v[88:91], v8 offset:30720
  v_mfma_f32_16x16x32_bf16 v[48:51], v[128:131], a[4:7], v[48:51]
  ds_read_b128 v[92:95], v8 offset:31744
  v_mfma_f32_16x16x32_bf16 v[20:23], v[132:135], a[0:3], v[20:23]
  buffer_load_dword v183, v182, s[32:35], s80 offen sc1
  v_mfma_f32_16x16x32_bf16 v[52:55], v[132:135], a[4:7], v[52:55]
  ds_read_b128 v[96:99], v8 offset:32768
  v_mfma_f32_16x16x32_bf16 v[24:27], v[136:139], a[0:3], v[24:27]
  ds_read_b128 v[100:103], v8 offset:33792
  v_mfma_f32_16x16x32_bf16 v[56:59], v[136:139], a[4:7], v[56:59]
  ds_read_b128 v[104:107], v8 offset:34816
  v_mfma_f32_16x16x32_bf16 v[28:31], v[140:143], a[0:3], v[28:31]
  buffer_load_dwordx4 a[32:35], v2, s[32:35], s72 offen offset:3072 sc1
  s_add_u32 s72, s72, 4096
  v_mfma_f32_16x16x32_bf16 v[60:63], v[140:143], a[4:7], v[60:63]
  ds_read_b128 v[108:111], v8 offset:35840
  v_mfma_f32_16x16x32_bf16 v[32:35], v[144:147], a[0:3], v[32:35]
  ds_read_b128 v[112:115], v8 offset:36864
  v_mfma_f32_16x16x32_bf16 v[64:67], v[144:147], a[4:7], v[64:67]
  ds_read_b128 v[116:119], v9 offset:37888
  v_mfma_f32_16x16x32_bf16 v[36:39], a[0:3], v[148:151], v[36:39]
  buffer_load_dwordx4 a[36:39], v2, s[32:35], s73 offen offset:3072 sc1
  s_add_u32 s73, s73, 4096
  v_mfma_f32_16x16x32_bf16 v[68:71], a[4:7], v[148:151], v[68:71]
  v_mfma_f32_16x16x32_bf16 v[40:43], a[0:3], v[152:155], v[40:43]
  v_mfma_f32_16x16x32_bf16 v[72:75], a[4:7], v[152:155], v[72:75]
  v_mfma_f32_16x16x32_bf16 v[44:47], a[0:3], v[156:159], v[44:47]
  buffer_load_dwordx4 a[40:43], v2, s[32:35], s72 offen offset:0 sc1
  v_mfma_f32_16x16x32_bf16 v[76:79], a[4:7], v[156:159], v[76:79]
  s_cmp_lg_u32 s3, 3
  s_cbranch_scc1 HK_31
  v_mfma_f32_16x16x32_bf16 v[80:83], v[136:139], a[250:253], v[80:83]
  v_mfma_f32_16x16x32_bf16 v[84:87], v[140:143], a[250:253], v[84:87]
  v_mfma_f32_16x16x32_bf16 v[120:123], v[144:147], a[250:253], v[120:123]
  v_mfma_f32_16x16x32_bf16 v[124:127], a[250:253], v[148:151], v[124:127]
  v_mfma_f32_16x16x32_bf16 v[160:163], a[250:253], v[152:155], v[160:163]
  v_mfma_f32_16x16x32_bf16 v[164:167], a[250:253], v[156:159], v[164:167]
HK_31:
  s_waitcnt vmcnt(9) lgkmcnt(0)
  v_mfma_f32_16x16x32_bf16 v[16:19], v[88:91], a[8:11], v[16:19]
  ds_read_b128 v[128:131], v8 offset:38400
  v_mfma_f32_16x16x32_bf16 v[48:51], v[88:91], a[12:15], v[48:51]
  ds_read_b128 v[132:135], v8 offset:39424
  v_mfma_f32_16x16x32_bf16 v[20:23], v[92:95], a[8:11], v[20:23]
  buffer_load_dwordx4 a[44:47], v2, s[32:35], s73 offen offset:0 sc1
  v_mfma_f32_16x16x32_bf16 v[52:55], v[92:95], a[12:15], v[52:55]
  ds_read_b128 v[136:139], v8 offset:40448
  v_mfma_f32_16x16x32_bf16 v[24:27], v[96:99], a[8:11], v[24:27]
  ds_read_b128 v[140:143], v8 offset:41472
  v_mfma_f32_16x16x32_bf16 v[56:59], v[96:99], a[12:15], v[56:59]
  ds_read_b128 v[144:147], v8 offset:42496
  v_mfma_f32_16x16x32_bf16 v[28:31], v[100:103], a[8:11], v[28:31]
  buffer_load_dwordx4 a[48:51], v2, s[32:35], s72 offen offset:1024 sc1
  v_mfma_f32_16x16x32_bf16 v[60:63], v[100:103], a[12:15], v[60:63]
  ds_read_b128 v[148:151], v8 offset:43520
  v_mfma_f32_16x16x32_bf16 v[32:35], v[104:107], a[8:11], v[32:35]
  ds_read_b128 v[152:155], v8 offset:44544
  v_mfma_f32_16x16x32_bf16 v[64:67], v[104:107], a[12:15], v[64:67]
  ds_read_b128 v[156:159], v9 offset:45568
  v_mfma_f32_16x16x32_bf16 v[36:39], a[8:11], v[108:111], v[36:39]
  buffer_load_dwordx4 a[52:55], v2, s[32:35], s73 offen offset:1024 sc1
  v_mfma_f32_16x16x32_bf16 v[68:71], a[12:15], v[108:111], v[68:71]
  v_mfma_f32_16x16x32_bf16 v[40:43], a[8:11], v[112:115], v[40:43]
  v_mfma_f32_16x16x32_bf16 v[72:75], a[12:15], v[112:115], v[72:75]
  v_mfma_f32_16x16x32_bf16 v[44:47], a[8:11], v[116:119], v[44:47]
  buffer_load_dwordx4 a[56:59], v2, s[32:35], s72 offen offset:2048 sc1
  v_mfma_f32_16x16x32_bf16 v[76:79], a[12:15], v[116:119], v[76:79]
  s_cmp_lg_u32 s3, 0
  s_cbranch_scc1 HK_32
  v_mfma_f32_16x16x32_bf16 v[80:83], v[96:99], a[88:91], v[80:83]
  v_mfma_f32_16x16x32_bf16 v[84:87], v[100:103], a[88:91], v[84:87]
  v_mfma_f32_16x16x32_bf16 v[120:123], v[104:107], a[88:91], v[120:123]
  v_mfma_f32_16x16x32_bf16 v[124:127], a[88:91], v[108:111], v[124:127]
  v_mfma_f32_16x16x32_bf16 v[160:163], a[88:91], v[112:115], v[160:163]
  v_mfma_f32_16x16x32_bf16 v[164:167], a[88:91], v[116:119], v[164:167]
HK_32:
  s_waitcnt vmcnt(11) lgkmcnt(0)
  v_mfma_f32_16x16x32_bf16 v[16:19], v[128:131], a[16:19], v[16:19]
  ds_read_b128 v[88:91], v8 offset:46080
  v_mfma_f32_16x16x32_bf16 v[48:51], v[128:131], a[20:23], v[48:51]
  ds_read_b128 v[92:95], v8 offset:47104
  v_mfma_f32_16x16x32_bf16 v[20:23], v[132:135], a[16:19], v[20:23]
  buffer_load_dwordx4 a[60:63], v2, s[32:35], s73 offen offset:2048 sc1
  v_mfma_f32_16x16x32_bf16 v[52:55], v[132:135], a[20:23], v[52:55]
  ds_read_b128 v[96:99], v8 offset:48128
  v_mfma_f32_16x16x32_bf16 v[24:27], v[136:139], a[16:19], v[24:27]
  ds_read_b128 v[100:103], v8 offset:49152
  v_mfma_f32_16x16x32_bf16 v[56:59], v[136:139], a[20:23], v[56:59]
  ds_read_b128 v[104:107], v8 offset:50176
  v_mfma_f32_16x16x32_bf16 v[28:31], v[140:143], a[16:19], v[28:31]
  buffer_load_dwordx4 a[64:67], v2, s[32:35], s72 offen offset:3072 sc1
  v_mfma_f32_16x16x32_bf16 v[60:63], v[140:143], a[20:23], v[60:63]
  ds_read_b128 v[108:111], v8 offset:51200
  v_mfma_f32_16x16x32_bf16 v[32:35], v[144:147], a[16:19], v[32:35]
  ds_read_b128 v[112:115], v8 offset:52224
  v_mfma_f32_16x16x32_bf16 v[64:67], v[144:147], a[20:23], v[64:67]
  ds_read_b128 v[116:119], v9 offset:53248
  v_mfma_f32_16x16x32_bf16 v[36:39], a[16:19], v[148:151], v[36:39]
  buffer_load_dwordx4 a[68:71], v2, s[32:35], s73 offen offset:3072 sc1
  v_mfma_f32_16x16x32_bf16 v[68:71], a[20:23], v[148:151], v[68:71]
  v_mfma_f32_16x16x32_bf16 v[40:43], a[16:19], v[152:155], v[40:43]
  v_mfma_f32_16x16x32_bf16 v[72:75], a[20:23], v[152:155], v[72:75]
  v_mfma_f32_16x16x32_bf16 v[44:47], a[16:19], v[156:159], v[44:47]
  buffer_load_dwordx4 a[216:219], v190, s[36:39], s61 offen offset:0 nt
  v_mfma_f32_16x16x32_bf16 v[76:79], a[20:23], v[156:159], v[76:79]
  s_cmp_lg_u32 s3, 1
  s_cbranch_scc1 HK_33
  v_mfma_f32_16x16x32_bf16 v[80:83], v[136:139], a[88:91], v[80:83]
  v_mfma_f32_16x16x32_bf16 v[84:87], v[140:143], a[88:91], v[84:87]
  v_mfma_f32_16x16x32_bf16 v[120:123], v[144:147], a[88:91], v[120:123]
  v_mfma_f32_16x16x32_bf16 v[124:127], a[88:91], v[148:151], v[124:127]
  v_mfma_f32_16x16x32_bf16 v[160:163], a[88:91], v[152:155], v[160:163]
  v_mfma_f32_16x16x32_bf16 v[164:167], a[88:91], v[156:159], v[164:167]
HK_33:
  s_waitcnt vmcnt(12) lgkmcnt(0)
  v_mfma_f32_16x16x32_bf16 v[16:19], v[88:91], a[24:27], v[16:19]
  ds_read_b128 v[128:131], v8 offset:53760
  ds_read_b128 v[192:195], v10 offset:2048
  v_mfma_f32_16x16x32_bf16 v[48:51], v[88:91], a[28:31], v[48:51]
  ds_read_b128 v[132:135], v8 offset:54784
  ds_read_b128 v[196:199], v10 offset:3072
  v_mfma_f32_16x16x32_bf16 v[20:23], v[92:95], a[24:27], v[20:23]
  ds_read_b128 v[136:139], v8 offset:55808
  ds_read_b128 v[200:203], v10 offset:4096
  v_mfma_f32_16x16x32_bf16 v[52:55], v[92:95], a[28:31], v[52:55]
  buffer_load_dwordx4 a[220:223], v190, s[36:39], s61 offen offset:128 nt
  v_mfma_f32_16x16x32_bf16 v[24:27], v[96:99], a[24:27], v[24:27]
  ds_read_b128 v[140:143], v8 offset:56832
  ds_read_b128 v[204:207], v10 offset:5120
  v_mfma_f32_16x16x32_bf16 v[56:59], v[96:99], a[28:31], v[56:59]
  ds_read_b128 v[144:147], v8 offset:57856
  ds_read_b128 v[208:211], v10 offset:6144
  v_mfma_f32_16x16x32_bf16 v[28:31], v[100:103], a[24:27], v[28:31]
  ds_read_b128 v[148:151], v8 offset:58880
  ds_read_b128 v[212:215], v11 offset:7168
  v_mfma_f32_16x16x32_bf16 v[60:63], v[100:103], a[28:31], v[60:63]
  ds_read_b128 v[152:155], v8 offset:59904
  v_mfma_f32_16x16x32_bf16 v[32:35], v[104:107], a[24:27], v[32:35]
  buffer_load_dwordx4 a[224:227], v190, s[36:39], s61 offen offset:256 nt
  v_mfma_f32_16x16x32_bf16 v[64:67], v[104:107], a[28:31], v[64:67]
  ds_read_b128 v[156:159], v9 offset:60928
  v_mfma_f32_16x16x32_bf16 v[36:39], a[24:27], v[108:111], v[36:39]
  v_mfma_f32_16x16x32_bf16 v[68:71], a[28:31], v[108:111], v[68:71]
  v_mfma_f32_16x16x32_bf16 v[40:43], a[24:27], v[112:115], v[40:43]
  v_mfma_f32_16x16x32_bf16 v[72:75], a[28:31], v[112:115], v[72:75]
  buffer_load_dwordx4 a[228:231], v190, s[36:39], s61 offen offset:384 nt
  v_mfma_f32_16x16x32_bf16 v[44:47], a[24:27], v[116:119], v[44:47]
  v_mfma_f32_16x16x32_bf16 v[76:79], a[28:31], v[116:119], v[76:79]
  s_cmp_lg_u32 s3, 2
  s_cbranch_scc1 HK_34
  v_mfma_f32_16x16x32_bf16 v[80:83], v[96:99], a[88:91], v[80:83]
  v_mfma_f32_16x16x32_bf16 v[84:87], v[100:103], a[88:91], v[84:87]
  v_mfma_f32_16x16x32_bf16 v[120:123], v[104:107], a[88:91], v[120:123]
  v_mfma_f32_16x16x32_bf16 v[124:127], a[88:91], v[108:111], v[124:127]
  v_mfma_f32_16x16x32_bf16 v[160:163], a[88:91], v[112:115], v[160:163]
  v_mfma_f32_16x16x32_bf16 v[164:167], a[88:91], v[116:119], v[164:167]
HK_34:
  s_waitcnt vmcnt(12) lgkmcnt(0)
  v_cmp_ne_u32 vcc, s4, v183
  s_cbranch_vccz FOK_35
  s_mov_b64 exec, vcc
  s_movk_i32 s5, 0
POLL_36:
  buffer_load_dword v183, v182, s[32:35], s80 offen sc1
  s_addk_i32 s5, 1
  s_waitcnt vmcnt(0)
  v_cmp_ne_u32 vcc, s4, v183
  s_cmpk_ge_u32 s5, 20000
  s_cbranch_scc1 POLLX_37
  s_cbranch_vccz POLLX_37
  s_mov_b64 exec, vcc
  s_sleep 8
  s_branch POLL_36
POLLX_37:
  s_mov_b64 exec, -1
FOK_35:
  v_mfma_f32_16x16x32_bf16 v[16:19], v[128:131], a[32:35], v[16:19]
  v_add_u32 v8, 61440, v8
  v_add_u32 v9, 61440, v9
  v_mfma_f32_16x16x32_bf16 v[48:51], v[128:131], a[36:39], v[48:51]
  ds_read_b128 v[88:91], v8 offset:0
  v_mfma_f32_16x16x32_bf16 v[20:23], v[132:135], a[32:35], v[20:23]
  ds_read_b128 v[92:95], v8 offset:1024
  v_mfma_f32_16x16x32_bf16 v[52:55], v[132:135], a[36:39], v[52:55]
  buffer_load_dwordx4 a[196:199], v188, s[52:55], s90 offen nt
  s_add_u32 s90, s90, 61440
  v_mfma_f32_16x16x32_bf16 v[24:27], v[136:139], a[32:35], v[24:27]
  ds_read_b128 v[96:99], v8 offset:2048
  v_mfma_f32_16x16x32_bf16 v[56:59], v[136:139], a[36:39], v[56:59]
  ds_read_b128 v[100:103], v8 offset:3072
  v_mfma_f32_16x16x32_bf16 v[28:31], v[140:143], a[32:35], v[28:31]
  ds_read_b128 v[104:107], v8 offset:4096
  v_mfma_f32_16x16x32_bf16 v[60:63], v[140:143], a[36:39], v[60:63]
  ds_read_b128 v[108:111], v8 offset:5120
  v_mfma_f32_16x16x32_bf16 v[32:35], v[144:147], a[32:35], v[32:35]
  buffer_load_dwordx4 a[200:203], v188, s[52:55], s90 offen nt
  s_add_u32 s90, s90, 61440
  v_mfma_f32_16x16x32_bf16 v[64:67], v[144:147], a[36:39], v[64:67]
  ds_read_b128 v[112:115], v8 offset:6144
  v_mfma_f32_16x16x32_bf16 v[36:39], a[32:35], v[148:151], v[36:39]
  ds_read_b128 v[116:119], v9 offset:7168
  v_mfma_f32_16x16x32_bf16 v[68:71], a[36:39], v[148:151], v[68:71]
  v_mfma_f32_16x16x32_bf16 v[40:43], a[32:35], v[152:155], v[40:43]
  v_mfma_f32_16x16x32_bf16 v[72:75], a[36:39], v[152:155], v[72:75]
  buffer_load_dwordx4 a[204:207], v188, s[52:55], s90 offen nt
  s_add_u32 s90, s90, 61440
  v_mfma_f32_16x16x32_bf16 v[44:47], a[32:35], v[156:159], v[44:47]
  v_mfma_f32_16x16x32_bf16 v[76:79], a[36:39], v[156:159], v[76:79]
  v_mfma_f32_16x16x32_bf16 v[80:83], v[192:195], a[92:95], v[80:83]
  v_mfma_f32_16x16x32_bf16 v[84:87], v[196:199], a[92:95], v[84:87]
  v_mfma_f32_16x16x32_bf16 v[120:123], v[200:203], a[92:95], v[120:123]
  v_mfma_f32_16x16x32_bf16 v[124:127], a[92:95], v[204:207], v[124:127]
  v_mfma_f32_16x16x32_bf16 v[160:163], a[92:95], v[208:211], v[160:163]
  v_mfma_f32_16x16x32_bf16 v[164:167], a[92:95], v[212:215], v[164:167]
  s_cmp_lg_u32 s3, 3
  s_cbranch_scc1 HK_38
  v_mfma_f32_16x16x32_bf16 v[80:83], v[136:139], a[88:91], v[80:83]
  v_mfma_f32_16x16x32_bf16 v[84:87], v[140:143], a[88:91], v[84:87]
  v_mfma_f32_16x16x32_bf16 v[120:123], v[144:147], a[88:91], v[120:123]
  v_mfma_f32_16x16x32_bf16 v[124:127], a[88:91], v[148:151], v[124:127]
  v_mfma_f32_16x16x32_bf16 v[160:163], a[88:91], v[152:155], v[160:163]
  v_mfma_f32_16x16x32_bf16 v[164:167], a[88:91], v[156:159], v[164:167]
HK_38:
  s_waitcnt vmcnt(13) lgkmcnt(0)
  v_mfma_f32_16x16x32_bf16 v[16:19], v[88:91], a[40:43], v[16:19]
  ds_read_b128 v[128:131], v8 offset:7680
  ds_read_b128 v[132:135], v8 offset:8704
  v_mfma_f32_16x16x32_bf16 v[48:51], v[88:91], a[44:47], v[48:51]
  ds_read_b128 v[136:139], v8 offset:9728
  ds_read_b128 v[140:143], v8 offset:10752
  v_mfma_f32_16x16x32_bf16 v[20:23], v[92:95], a[40:43], v[20:23]
  ds_read_b128 v[144:147], v8 offset:11776
  ds_read_b128 v[148:151], v8 offset:12800
  v_mfma_f32_16x16x32_bf16 v[52:55], v[92:95], a[44:47], v[52:55]
  buffer_load_dwordx4 a[208:211], v188, s[52:55], s90 offen nt
  s_add_u32 s90, s90, 61440
  v_mfma_f32_16x16x32_bf16 v[24:27], v[96:99], a[40:43], v[24:27]
  ds_read_b128 v[152:155], v8 offset:13824
  ds_read_b128 v[156:159], v9 offset:14848
  v_mfma_f32_16x16x32_bf16 v[56:59], v[96:99], a[44:47], v[56:59]
  ds_write_b128 v12, v[80:83] offset:0
  v_mfma_f32_16x16x32_bf16 v[28:31], v[100:103], a[40:43], v[28:31]
  ds_write_b128 v12, v[84:87] offset:1024
  v_mfma_f32_16x16x32_bf16 v[60:63], v[100:103], a[44:47], v[60:63]
  ds_write_b128 v12, v[120:123] offset:2048
  v_mfma_f32_16x16x32_bf16 v[32:35], v[104:107], a[40:43], v[32:35]
  buffer_load_dwordx4 a[212:215], v188, s[52:55], s90 offen nt
  v_mfma_f32_16x16x32_bf16 v[64:67], v[104:107], a[44:47], v[64:67]
  ds_write_b128 v12, v[124:127] offset:3072
  v_mfma_f32_16x16x32_bf16 v[36:39], a[40:43], v[108:111], v[36:39]
  ds_write_b128 v12, v[160:163] offset:4096
  v_mfma_f32_16x16x32_bf16 v[68:71], a[44:47], v[108:111], v[68:71]
  ds_write_b128 v12, v[164:167] offset:5120
  v_mfma_f32_16x16x32_bf16 v[40:43], a[40:43], v[112:115], v[40:43]
  v_mfma_f32_16x16x32_bf16 v[72:75], a[44:47], v[112:115], v[72:75]
  buffer_load_dwordx4 a[96:99], v2, s[32:35], s81 offen offset:0 sc1
  v_mfma_f32_16x16x32_bf16 v[44:47], a[40:43], v[116:119], v[44:47]
  v_mfma_f32_16x16x32_bf16 v[76:79], a[44:47], v[116:119], v[76:79]
  s_waitcnt vmcnt(14) lgkmcnt(0)
  s_barrier
  v_mfma_f32_16x16x32_bf16 v[16:19], v[128:131], a[48:51], v[16:19]
  ds_read_b128 v[88:91], v8 offset:15360
  ds_read_b128 v[192:195], v13 offset:0
  v_mfma_f32_16x16x32_bf16 v[48:51], v[128:131], a[52:55], v[48:51]
  ds_read_b128 v[92:95], v8 offset:16384
  ds_read_b128 v[196:199], v13 offset:6144
  v_mfma_f32_16x16x32_bf16 v[20:23], v[132:135], a[48:51], v[20:23]
  ds_read_b128 v[96:99], v8 offset:17408
  ds_read_b128 v[200:203], v13 offset:12288
  v_mfma_f32_16x16x32_bf16 v[52:55], v[132:135], a[52:55], v[52:55]
  buffer_load_dwordx4 a[100:103], v2, s[32:35], s81 offen offset:1024 sc1
  v_mfma_f32_16x16x32_bf16 v[24:27], v[136:139], a[48:51], v[24:27]
  ds_read_b128 v[100:103], v8 offset:18432
  ds_read_b128 v[204:207], v13 offset:18432
  v_mfma_f32_16x16x32_bf16 v[56:59], v[136:139], a[52:55], v[56:59]
  ds_read_b128 v[104:107], v8 offset:19456
  ds_read_b128 v[208:211], v13 offset:3072
  v_mfma_f32_16x16x32_bf16 v[28:31], v[140:143], a[48:51], v[28:31]
  ds_read_b128 v[108:111], v8 offset:20480
  ds_read_b128 v[212:215], v13 offset:9216
  v_mfma_f32_16x16x32_bf16 v[60:63], v[140:143], a[52:55], v[60:63]
  ds_read_b128 v[112:115], v8 offset:21504
  ds_read_b128 v[216:219], v13 offset:15360
  v_mfma_f32_16x16x32_bf16 v[32:35], v[144:147], a[48:51], v[32:35]
  buffer_load_dwordx4 a[104:107], v2, s[32:35], s81 offen offset:2048 sc1
  v_mfma_f32_16x16x32_bf16 v[64:67], v[144:147], a[52:55], v[64:67]
  ds_read_b128 v[116:119], v9 offset:22528
  v_mfma_f32_16x16x32_bf16 v[36:39], a[48:51], v[148:151], v[36:39]
  v_mfma_f32_16x16x32_bf16 v[68:71], a[52:55], v[148:151], v[68:71]
  v_mfma_f32_16x16x32_bf16 v[40:43], a[48:51], v[152:155], v[40:43]
  v_mfma_f32_16x16x32_bf16 v[72:75], a[52:55], v[152:155], v[72:75]
  buffer_load_dwordx4 a[108:111], v2, s[32:35], s81 offen offset:3072 sc1
  v_mfma_f32_16x16x32_bf16 v[44:47], a[48:51], v[156:159], v[44:47]
  v_mfma_f32_16x16x32_bf16 v[76:79], a[52:55], v[156:159], v[76:79]
  s_waitcnt vmcnt(15) lgkmcnt(0)
  v_mfma_f32_16x16x32_bf16 v[16:19], v[88:91], a[56:59], v[16:19]
  ds_read_b128 v[128:131], v8 offset:23040
  ds_read_b128 v[220:223], v13 offset:21504
  v_mfma_f32_16x16x32_bf16 v[48:51], v[88:91], a[60:63], v[48:51]
  ds_read_b128 v[132:135], v8 offset:24064
  v_add_f32 v192, v192, v196
  v_mfma_f32_16x16x32_bf16 v[20:23], v[92:95], a[56:59], v[20:23]
  ds_read_b128 v[136:139], v8 offset:25088
  v_add_f32 v193, v193, v197
  v_mfma_f32_16x16x32_bf16 v[52:55], v[92:95], a[60:63], v[52:55]
  ds_read_b128 v[140:143], v8 offset:26112
  v_add_f32 v194, v194, v198
  v_mfma_f32_16x16x32_bf16 v[24:27], v[96:99], a[56:59], v[24:27]
  ds_read_b128 v[144:147], v8 offset:27136
  v_add_f32 v195, v195, v199
  v_mfma_f32_16x16x32_bf16 v[56:59], v[96:99], a[60:63], v[56:59]
  ds_read_b128 v[148:151], v8 offset:28160
  v_add_f32 v200, v200, v204
  v_mfma_f32_16x16x32_bf16 v[28:31], v[100:103], a[56:59], v[28:31]
  ds_read_b128 v[152:155], v8 offset:29184
  v_add_f32 v201, v201, v205
  v_mfma_f32_16x16x32_bf16 v[60:63], v[100:103], a[60:63], v[60:63]
  ds_read_b128 v[156:159], v9 offset:30208
  v_add_f32 v202, v202, v206
  v_mfma_f32_16x16x32_bf16 v[32:35], v[104:107], a[56:59], v[32:35]
  s_add_u32 s81, s81, 4096
  buffer_load_dwordx4 a[112:115], v2, s[32:35], s81 offen offset:0 sc1
  v_mfma_f32_16x16x32_bf16 v[64:67], v[104:107], a[60:63], v[64:67]
  v_add_f32 v203, v203, v207
  v_add_f32 v208, v208, v212
  v_mfma_f32_16x16x32_bf16 v[36:39], a[56:59], v[108:111], v[36:39]
  v_add_f32 v209, v209, v213
  v_add_f32 v210, v210, v214
  v_mfma_f32_16x16x32_bf16 v[68:71], a[60:63], v[108:111], v[68:71]
  v_add_f32 v211, v211, v215
  v_add_f32 v192, v192, v200
  v_mfma_f32_16x16x32_bf16 v[40:43], a[56:59], v[112:115], v[40:43]
  v_add_f32 v193, v193, v201
  v_add_f32 v194, v194, v202
  v_mfma_f32_16x16x32_bf16 v[72:75], a[60:63], v[112:115], v[72:75]
  v_add_f32 v195, v195, v203
  v_add_f32 v208, v208, v216
  v_mfma_f32_16x16x32_bf16 v[44:47], a[56:59], v[116:119], v[44:47]
  v_add_f32 v209, v209, v217
  v_add_f32 v210, v210, v218
  v_mfma_f32_16x16x32_bf16 v[76:79], a[60:63], v[116:119], v[76:79]
  v_add_f32 v211, v211, v219
  s_waitcnt vmcnt(14) lgkmcnt(0)
  v_mfma_f32_16x16x32_bf16 v[56:59], v[136:139], a[68:71], v[56:59]
  v_add_f32 v208, v208, v220
  v_add_f32 v209, v209, v221
  v_mfma_f32_16x16x32_bf16 v[60:63], v[140:143], a[68:71], v[60:63]
  v_add_f32 v210, v210, v222
  v_add_f32 v211, v211, v223
  v_mfma_f32_16x16x32_bf16 v[64:67], v[144:147], a[68:71], v[64:67]
  v_cvt_pk_bf16_f32 v196, v192, v193
  v_cvt_pk_bf16_f32 v197, v194, v195
  v_mfma_f32_16x16x32_bf16 v[68:71], a[68:71], v[148:151], v[68:71]
  v_cvt_pk_bf16_f32 v198, v208, v209
  v_cvt_pk_bf16_f32 v199, v210, v211
  v_mfma_f32_16x16x32_bf16 v[72:75], a[68:71], v[152:155], v[72:75]
  ds_write_b64 v175, v[196:197]
  ds_write_b64 v175, v[198:199] offset:1536
  v_mfma_f32_16x16x32_bf16 v[76:79], a[68:71], v[156:159], v[76:79]
  v_cvt_pk_bf16_f32 v100, v56, v57
  v_cvt_pk_bf16_f32 v101, v58, v59
  v_mfma_f32_16x16x32_bf16 v[24:27], v[136:139], a[64:67], v[24:27]
  ds_write_b64 v174, v[100:101] offset:3072
  v_cvt_pk_bf16_f32 v104, v60, v61
  v_mfma_f32_16x16x32_bf16 v[32:35], v[144:147], a[64:67], v[32:35]
  v_cvt_pk_bf16_f32 v105, v62, v63
  ds_write_b64 v174, v[104:105] offset:3584
  v_mfma_f32_16x16x32_bf16 v[28:31], v[140:143], a[64:67], v[28:31]
  v_cvt_pk_bf16_f32 v102, v64, v65
  v_cvt_pk_bf16_f32 v103, v66, v67
  v_mfma_f32_16x16x32_bf16 v[36:39], a[64:67], v[148:151], v[36:39]
  ds_write_b64 v174, v[102:103] offset:4096
  v_cvt_pk_bf16_f32 v110, v68, v69
  v_mfma_f32_16x16x32_bf16 v[40:43], a[64:67], v[152:155], v[40:43]
  v_cvt_pk_bf16_f32 v111, v70, v71
  ds_write_b64 v174, v[110:111] offset:4608
  v_mfma_f32_16x16x32_bf16 v[44:47], a[64:67], v[156:159], v[44:47]
  v_cvt_pk_bf16_f32 v116, v72, v73
  v_cvt_pk_bf16_f32 v117, v74, v75
  v_mfma_f32_16x16x32_bf16 v[48:51], v[128:131], a[68:71], v[48:51]
  ds_write_b64 v174, v[116:117] offset:5120
  v_cvt_pk_bf16_f32 v122, v76, v77
  v_mfma_f32_16x16x32_bf16 v[52:55], v[132:135], a[68:71], v[52:55]
  v_cvt_pk_bf16_f32 v123, v78, v79
  ds_write_b64 v174, v[122:123] offset:5632
  v_mfma_f32_16x16x32_bf16 v[16:19], v[128:131], a[64:67], v[16:19]
  v_cvt_pk_bf16_f32 v94, v24, v25
  v_cvt_pk_bf16_f32 v95, v26, v27
  v_mfma_f32_16x16x32_bf16 v[20:23], v[132:135], a[64:67], v[20:23]
  v_cvt_pk_bf16_f32 v96, v32, v33
  v_cvt_pk_bf16_f32 v97, v34, v35
  v_cvt_pk_bf16_f32 v98, v28, v29
  v_cvt_pk_bf16_f32 v99, v30, v31
  v_cvt_pk_bf16_f32 v108, v36, v37
  v_cvt_pk_bf16_f32 v109, v38, v39
  v_cvt_pk_bf16_f32 v114, v40, v41
  v_cvt_pk_bf16_f32 v115, v42, v43
  v_cvt_pk_bf16_f32 v120, v44, v45
  v_cvt_pk_bf16_f32 v121, v46, v47
  v_cvt_pk_bf16_f32 v132, v48, v49
  v_cvt_pk_bf16_f32 v133, v50, v51
  v_cvt_pk_bf16_f32 v138, v52, v53
  buffer_load_dwordx4 a[116:119], v2, s[32:35], s81 offen offset:1024 sc1
  v_cvt_pk_bf16_f32 v139, v54, v55
  v_mov_b32 v134, 0
  v_mov_b32 v136, v102
  v_mov_b32 v135, 0
  v_mov_b32 v137, v103
  v_cvt_pk_bf16_f32 v124, v16, v17
  v_cvt_pk_bf16_f32 v125, v18, v19
  v_cvt_pk_bf16_f32 v130, v20, v21
  v_cvt_pk_bf16_f32 v131, v22, v23
  v_mov_b32 v126, 0
  v_mov_b32 v128, v96
  buffer_load_dwordx4 a[120:123], v2, s[32:35], s81 offen offset:2048 sc1
  v_mov_b32 v127, 0
  v_mov_b32 v129, v97
  v_permlane32_swap_b32 v134, v136
  v_permlane32_swap_b32 v135, v137
  v_permlane32_swap_b32 v126, v128
  v_permlane32_swap_b32 v127, v129
  v_and_b32 v136, v173, v134
  v_and_b32 v137, v173, v135
  v_and_b32 v134, v172, v134
  v_and_b32 v135, v172, v135
  v_and_b32 v128, v173, v126
  buffer_load_dwordx4 a[124:127], v2, s[32:35], s81 offen offset:3072 sc1
  v_and_b32 v129, v173, v127
  v_and_b32 v126, v172, v126
  v_and_b32 v127, v172, v127
  s_waitcnt lgkmcnt(0)
  s_barrier
  ds_read_b64 v[88:89], v174 offset:0
  ds_read_b64 v[92:93], v174 offset:512
  ds_read_b64 v[90:91], v174 offset:1024
  ds_read_b64 v[106:107], v174 offset:1536
  ds_read_b64 v[112:113], v174 offset:2048
  ds_read_b64 v[118:119], v174 offset:2560
  v_mfma_f32_16x16x32_bf16 v[20:23], v[100:103], v[132:135], 0
  v_mfma_f32_16x16x32_bf16 v[16:19], v[94:97], v[132:135], 0
  v_mfma_f32_16x16x32_bf16 v[28:31], v[102:105], v[136:139], 0
  v_mfma_f32_16x16x32_bf16 v[24:27], v[96:99], v[136:139], 0
  v_mfma_f32_16x16x32_bf16 v[36:39], v[94:97], v[124:127], 0
  v_mfma_f32_16x16x32_bf16 v[44:47], v[96:99], v[128:131], 0
  s_waitcnt lgkmcnt(3)
  v_mfma_f32_16x16x32_bf16 v[32:35], v[88:91], v[124:127], v[176:179]
  v_mfma_f32_16x16x32_bf16 v[40:43], v[90:93], v[128:131], v[176:179]
  s_add_u32 s78, s76, 5242880
  s_lshl_b32 s5, s65, 8
  s_add_u32 s80, s78, s5
  s_add_u32 s80, s80, 16384
  s_lshl_b32 s5, s65, 10
  s_add_u32 s78, s78, s5
  s_add_u32 s79, s78, 20480
  v_cndmask_b32 v16, v16, v17, s[44:45]
  v_cndmask_b32 v20, v20, v21, s[44:45]
  v_cndmask_b32 v18, v18, v19, s[44:45]
  v_cndmask_b32 v22, v22, v23, s[44:45]
  v_cndmask_b32 v48, v16, v20, s[46:47]
  v_cndmask_b32 v49, v18, v22, s[56:57]
  v_cndmask_b32 v24, v24, v25, s[44:45]
  v_cndmask_b32 v28, v28, v29, s[44:45]
  s_add_u32 s81, s81, 4096
  buffer_load_dwordx4 a[128:131], v2, s[32:35], s81 offen offset:0 sc1
  v_cndmask_b32 v26, v26, v27, s[44:45]
  v_cndmask_b32 v30, v30, v31, s[44:45]
  v_cndmask_b32 v50, v24, v28, s[46:47]
  v_cndmask_b32 v51, v26, v30, s[56:57]
  v_cndmask_b32 v32, v32, v33, s[44:45]
  v_cndmask_b32 v36, v36, v37, s[44:45]
  v_cndmask_b32 v34, v34, v35, s[44:45]
  v_cndmask_b32 v38, v38, v39, s[44:45]
  v_cndmask_b32 v52, v32, v36, s[46:47]
  v_cndmask_b32 v53, v34, v38, s[56:57]
  v_cndmask_b32 v40, v40, v41, s[44:45]
  buffer_load_dwordx4 a[132:135], v2, s[32:35], s81 offen offset:1024 sc1
  v_cndmask_b32 v44, v44, v45, s[44:45]
  v_cndmask_b32 v42, v42, v43, s[44:45]
  v_cndmask_b32 v46, v46, v47, s[44:45]
  v_cndmask_b32 v54, v40, v44, s[46:47]
  v_cndmask_b32 v55, v42, v46, s[56:57]
  v_max_f32 v56, v48, v49
  v_max_f32 v57, v50, v51
  v_max_f32 v58, v52, v53
  v_max_f32 v59, v54, v55
  v_mov_b32 v60, v56
  v_mov_b32 v61, v57
  buffer_load_dwordx4 a[136:139], v2, s[32:35], s81 offen offset:2048 sc1
  v_mov_b32 v62, v58
  v_mov_b32 v63, v59
  v_permlane32_swap_b32 v56, v60
  v_permlane32_swap_b32 v57, v61
  v_permlane32_swap_b32 v58, v62
  v_permlane32_swap_b32 v59, v63
  v_max_f32 v56, v56, v60
  v_max_f32 v57, v57, v61
  v_max_f32 v58, v58, v62
  v_max_f32 v59, v59, v63
  v_mov_b32 v60, v56
  buffer_load_dwordx4 a[140:143], v2, s[32:35], s81 offen offset:3072 sc1
  v_mov_b32 v61, v57
  v_mov_b32 v62, v58
  v_mov_b32 v63, v59
  v_permlane16_swap_b32 v56, v60
  v_permlane16_swap_b32 v57, v61
  v_permlane16_swap_b32 v58, v62
  v_permlane16_swap_b32 v59, v63
  v_max_f32 v56, v56, v60
  v_max_f32 v57, v57, v61
  v_max_f32 v58, v58, v62
  v_max_f32 v59, v59, v63
  s_add_u32 s81, s81, 4096
  buffer_load_dwordx4 a[144:147], v2, s[32:35], s81 offen offset:0 sc1
  s_mov_b32 s7, 0x3ea52b5c
  v_mul_f32 v56, s7, v56
  v_mul_f32 v57, s7, v57
  v_mul_f32 v58, s7, v58
  v_mul_f32 v59, s7, v59
  v_fma_f32 v48, v48, s7, -v56
  v_fma_f32 v49, v49, s7, -v56
  v_fma_f32 v50, v50, s7, -v57
  v_fma_f32 v51, v51, s7, -v57
  v_fma_f32 v52, v52, s7, -v58
  v_fma_f32 v53, v53, s7, -v58
  buffer_load_dwordx4 a[148:151], v2, s[32:35], s81 offen offset:1024 sc1
  v_fma_f32 v54, v54, s7, -v59
  v_fma_f32 v55, v55, s7, -v59
  v_exp_f32 v48, v48
  v_exp_f32 v49, v49
  v_exp_f32 v50, v50
  v_exp_f32 v51, v51
  v_exp_f32 v52, v52
  v_exp_f32 v53, v53
  v_exp_f32 v54, v54
  v_exp_f32 v55, v55
  v_add_f32 v56, v48, v49
  buffer_load_dwordx4 a[152:155], v2, s[32:35], s81 offen offset:2048 sc1
  v_add_f32 v57, v50, v51
  v_add_f32 v58, v52, v53
  v_add_f32 v59, v54, v55
  v_mov_b32 v60, v56
  v_mov_b32 v61, v57
  v_mov_b32 v62, v58
  v_mov_b32 v63, v59
  v_permlane32_swap_b32 v56, v60
  v_permlane32_swap_b32 v57, v61
  v_permlane32_swap_b32 v58, v62
  v_permlane32_swap_b32 v59, v63
  buffer_load_dwordx4 a[156:159], v2, s[32:35], s81 offen offset:3072 sc1
  v_pk_add_f32 v[56:57], v[56:57], v[60:61]
  v_pk_add_f32 v[58:59], v[58:59], v[62:63]
  v_mov_b32 v60, v56
  v_mov_b32 v61, v57
  v_mov_b32 v62, v58
  v_mov_b32 v63, v59
  v_permlane16_swap_b32 v56, v60
  v_permlane16_swap_b32 v57, v61
  v_permlane16_swap_b32 v58, v62
  v_permlane16_swap_b32 v59, v63
  v_pk_add_f32 v[56:57], v[56:57], v[60:61]
  s_add_u32 s81, s81, 4096
  buffer_load_dwordx4 a[160:163], v2, s[32:35], s81 offen offset:0 sc1
  v_pk_add_f32 v[58:59], v[58:59], v[62:63]
  s_mov_b32 s63, 851968
  buffer_load_dword v187, v186, s[32:35], s63 offen sc1
  v_rcp_f32 v56, v56
  v_rcp_f32 v57, v57
  v_rcp_f32 v58, v58
  v_rcp_f32 v59, v59
  v_pk_mul_f32 v[48:49], v[48:49], v[56:57] op_sel_hi:[1,0]
  v_pk_mul_f32 v[50:51], v[50:51], v[56:57] op_sel:[0,1]
  v_pk_mul_f32 v[52:53], v[52:53], v[58:59] op_sel_hi:[1,0]
  v_pk_mul_f32 v[54:55], v[54:55], v[58:59] op_sel:[0,1]
  v_cvt_pk_bf16_f32 v48, v48, v48
  v_cvt_pk_bf16_f32 v49, v49, v49
  v_cvt_pk_bf16_f32 v50, v50, v50
  v_cvt_pk_bf16_f32 v51, v51, v51
  v_cvt_pk_bf16_f32 v52, v52, v52
  v_cvt_pk_bf16_f32 v53, v53, v53
  v_cvt_pk_bf16_f32 v54, v54, v54
  v_cvt_pk_bf16_f32 v55, v55, v55
  v_and_b32 v64, v168, v48
  v_and_b32 v65, v169, v49
  v_and_b32 v66, v170, v48
  v_and_b32 v67, v171, v49
  v_and_b32 v68, v168, v50
  v_and_b32 v69, v169, v51
  v_and_b32 v70, v170, v50
  v_and_b32 v71, v171, v51
  v_and_b32 v72, v168, v52
  v_and_b32 v73, v169, v53
  v_and_b32 v74, v170, v52
  v_and_b32 v75, v171, v53
  v_and_b32 v76, v168, v54
  v_and_b32 v77, v169, v55
  v_and_b32 v78, v170, v54
  v_and_b32 v79, v171, v55
  s_waitcnt lgkmcnt(0)
  v_mfma_f32_16x16x32_bf16 v[16:19], v[108:111], v[64:67], 0
  v_mfma_f32_16x16x32_bf16 v[24:27], v[114:117], v[68:71], 0
  v_mfma_f32_16x16x32_bf16 v[32:35], v[106:109], v[72:75], 0
  v_mfma_f32_16x16x32_bf16 v[40:43], v[112:115], v[76:79], 0
  v_mfma_f32_16x16x32_bf16 v[20:23], v[120:123], v[64:67], 0
  v_mfma_f32_16x16x32_bf16 v[28:31], v[120:123], v[68:71], 0
  v_mfma_f32_16x16x32_bf16 v[36:39], v[118:121], v[72:75], 0
  v_mfma_f32_16x16x32_bf16 v[44:47], v[118:121], v[76:79], 0
  s_nop 0
  v_cvt_pk_bf16_f32 v92, v16, v17
  v_cvt_pk_bf16_f32 v93, v18, v19
  v_cvt_pk_bf16_f32 v94, v24, v25
  v_cvt_pk_bf16_f32 v95, v26, v27
  buffer_store_dwordx4 v[92:95], v2, s[32:35], s79 offen sc1
  v_cvt_pk_bf16_f32 v88, v32, v33
  v_cvt_pk_bf16_f32 v89, v34, v35
  v_cvt_pk_bf16_f32 v90, v40, v41
  v_cvt_pk_bf16_f32 v91, v42, v43
  buffer_store_dwordx4 v[88:91], v2, s[32:35], s78 offen sc1
  v_cvt_pk_bf16_f32 v96, v36, v37
  v_cvt_pk_bf16_f32 v97, v38, v39
  v_cvt_pk_bf16_f32 v98, v28, v29
  v_cvt_pk_bf16_f32 v99, v30, v31
  v_cvt_pk_bf16_f32 v100, v20, v21
  v_cvt_pk_bf16_f32 v101, v22, v23
  v_cvt_pk_bf16_f32 v102, v44, v45
  v_cvt_pk_bf16_f32 v103, v46, v47
  v_permlane16_swap_b32 v96, v100
  v_permlane16_swap_b32 v97, v101
  v_permlane16_swap_b32 v102, v98
  v_permlane16_swap_b32 v103, v99
  s_mov_b32 exec_hi, 0
  buffer_store_dwordx4 v[96:99], v180, s[32:35], s80 offen sc1
  s_mov_b64 exec, -1
  buffer_load_dwordx4 a[164:167], v2, s[32:35], s81 offen offset:1024 sc1
  s_lshl_b32 s5, s64, 4
  s_add_u32 s5, s5, s65
  s_lshl_b32 s5, s5, 2
  s_add_u32 s5, s5, s3
  s_lshl_b32 s5, s5, 7
  s_add_u32 s58, s5, 917504
  s_mov_b32 s59, s70
  s_mov_b32 s86, s71
  s_mov_b32 s60, s84
  buffer_load_dwordx4 a[168:171], v2, s[32:35], s81 offen offset:2048 sc1
  v_lshrrev_b32 v12, 3, v1
  v_lshlrev_b32 v12, 2, v12
  ds_bpermute_b32 v20, v12, v234 offset:0
  ds_bpermute_b32 v21, v12, v234 offset:32
  ds_bpermute_b32 v22, v12, v234 offset:64
  ds_bpermute_b32 v23, v12, v234 offset:96
  ds_bpermute_b32 v24, v12, v234 offset:128
  s_add_u32 s5, s3, 1
  s_and_b32 s5, s5, 3
  buffer_load_dwordx4 a[172:175], v2, s[32:35], s81 offen offset:3072 sc1
  s_lshl_b32 s7, s66, 2
  s_add_u32 s5, s5, s7
  s_mul_i32 s5, s5, 20480
  s_add_u32 s5, s5, 5242880
  s_add_u32 s68, s5, s93
  s_lshl_b32 s7, s3, 10
  s_add_u32 s7, s7, 16384
  s_add_u32 s72, s5, s7
  s_add_u32 s5, s3, 2
  buffer_load_dwordx4 a[176:179], v2, s[32:35], s82 offen offset:0 sc1
  s_and_b32 s5, s5, 3
  s_lshl_b32 s7, s66, 2
  s_add_u32 s5, s5, s7
  s_mul_i32 s5, s5, 20480
  s_add_u32 s5, s5, 5242880
  s_add_u32 s69, s5, s93
  s_lshl_b32 s7, s3, 10
  s_add_u32 s7, s7, 16384
  s_add_u32 s73, s5, s7
  buffer_load_dwordx4 a[180:183], v2, s[32:35], s82 offen offset:1024 sc1
  s_add_u32 s5, s3, 3
  s_and_b32 s5, s5, 3
  s_lshl_b32 s7, s66, 2
  s_add_u32 s5, s5, s7
  s_mul_i32 s5, s5, 20480
  s_add_u32 s5, s5, 5242880
  s_add_u32 s70, s5, s93
  s_lshl_b32 s7, s3, 10
  s_add_u32 s7, s7, 16384
  buffer_load_dwordx4 a[184:187], v2, s[32:35], s82 offen offset:2048 sc1
  s_add_u32 s74, s5, s7
  s_add_u32 s5, s3, 4
  s_and_b32 s5, s5, 3
  s_lshl_b32 s7, s66, 2
  s_add_u32 s5, s5, s7
  s_mul_i32 s5, s5, 20480
  s_add_u32 s5, s5, 5242880
  s_add_u32 s71, s5, s93
  s_lshl_b32 s7, s3, 10
  buffer_load_dwordx4 a[188:191], v2, s[32:35], s82 offen offset:3072 sc1
  s_add_u32 s7, s7, 16384
  s_add_u32 s75, s5, s7
  v_min_u32 v15, 7, v1
  v_and_b32 v14, 3, v15
  v_lshrrev_b32 v15, 2, v15
  v_lshl_add_u32 v14, v14, 2, v15
  v_lshlrev_b32 v14, 7, v14
  s_lshr_b32 s5, s66, 1
  s_lshl_b32 s5, s5, 2
  s_add_u32 s82, s82, 4096
  buffer_load_dwordx4 a[192:195], v2, s[32:35], s82 offen offset:0 sc1
  s_add_u32 s5, s5, s3
  s_lshl_b32 s5, s5, 3
  s_and_b32 s7, s66, 1
  s_add_u32 s5, s5, s7
  s_lshl_b32 s5, s5, 8
  s_add_u32 s78, s5, 917504
  s_getpc_b64 s[44:45]
L_pf1:
  s_mov_b32 s46, 19136
  s_mov_b32 s47, 0x20000
  s_lshr_b32 s5, s2, 3
  s_lshl_b32 s5, s5, 10
  v_min_u32 v234, 7, v1
  v_lshlrev_b32 v234, 7, v234
  s_cmp_lg_u32 s3, 1
  s_cbranch_scc1 PF_39
  buffer_load_dword v234, v234, s[44:47], s5 offen
PF_39:
  v_and_b32 v16, 7, v1
  v_lshlrev_b32 v16, 5, v16
  v_lshl_add_u32 v16, v5, 3, v16
  s_lshl_b32 s5, s3, 8
  s_add_u32 s5, s5, 160768
  v_add_u32 v16, s5, v16
  v_lshlrev_b32 v17, 2, v1
  v_add_u32 v17, 160768, v17
  s_and_b32 s5, s2, 3
  s_mul_i32 s5, s5, 30720
  s_lshl_b32 s6, s85, 9
  s_add_u32 s5, s5, s6
  s_add_u32 s61, s5, 131072
  s_lshl_b32 s6, s3, 4
  s_lshl_b64 s[94:95], 0xffff, s6
  s_mul_i32 s88, s67, 48
  s_mul_i32 s5, s3, 12
  s_add_u32 s88, s88, s5
  s_mul_i32 s88, s88, 5120
  s_add_u32 s88, s88, 24117248
  s_waitcnt vmcnt(11)
  v_cmp_ne_u32 vcc, s4, v187
  s_cbranch_vccz FOK_40
  s_mov_b64 exec, vcc
  s_movk_i32 s5, 0
POLL_41:
  buffer_load_dword v187, v186, s[32:35], s63 offen sc1
  s_addk_i32 s5, 1
  s_waitcnt vmcnt(0)
  v_cmp_ne_u32 vcc, s4, v187
  s_cmpk_ge_u32 s5, 20000
  s_cbranch_scc1 POLLX_42
  s_cbranch_vccz POLLX_42
  s_mov_b64 exec, vcc
  s_sleep 8
  s_branch POLL_41
POLLX_42:
  s_mov_b64 exec, -1
FOK_40:
  ds_write_b128 v181, a[216:219] offset:0
  ds_write_b128 v181, a[220:223] offset:128
  ds_write_b128 v181, a[224:227] offset:256
  ds_write_b128 v181, a[228:231] offset:384
  s_waitcnt vmcnt(8)
  s_mov_b64 exec, 1
  buffer_store_dword v235, v2, s[32:35], s58 offen offset:0 sc1
  s_mov_b64 exec, -1
  s_waitcnt lgkmcnt(0)
  s_barrier
  ds_read_b64_tr_b16 v[96:97], v185 offset:0
  ds_read_b64_tr_b16 v[98:99], v185 offset:2176
  ds_read_b64_tr_b16 v[100:101], v185 offset:8
  ds_read_b64_tr_b16 v[102:103], v185 offset:2184
  ds_read_b64_tr_b16 v[104:105], v185 offset:64
  ds_read_b64_tr_b16 v[106:107], v185 offset:2240
  ds_read_b64_tr_b16 v[108:109], v185 offset:72
  ds_read_b64_tr_b16 v[110:111], v185 offset:2248
  s_add_u32 s6, s59, 81920
  s_waitcnt lgkmcnt(6)
  buffer_store_dwordx4 v[96:99], v2, s[32:35], s59 offen offset:0 sc1
  s_waitcnt lgkmcnt(4)
  buffer_store_dwordx4 v[100:103], v2, s[32:35], s59 offen offset:1024 sc1
  s_waitcnt lgkmcnt(2)
  buffer_store_dwordx4 v[104:107], v2, s[32:35], s6 offen offset:0 sc1
  s_waitcnt lgkmcnt(0)
  buffer_store_dwordx4 v[108:111], v2, s[32:35], s6 offen offset:1024 sc1
  s_cmp_eq_u32 s60, 0
  s_cbranch_scc1 NOMOD_43
  v_accvgpr_read_b32 v64, a196
  v_accvgpr_read_b32 v65, a197
  v_accvgpr_read_b32 v66, a198
  v_accvgpr_read_b32 v67, a199
  v_accvgpr_read_b32 v68, a200
  v_accvgpr_read_b32 v69, a201
  v_accvgpr_read_b32 v70, a202
  v_accvgpr_read_b32 v71, a203
  v_accvgpr_read_b32 v72, a204
  v_accvgpr_read_b32 v73, a205
  v_accvgpr_read_b32 v74, a206
  v_accvgpr_read_b32 v75, a207
  v_accvgpr_read_b32 v76, a208
  v_accvgpr_read_b32 v77, a209
  v_accvgpr_read_b32 v78, a210
  v_accvgpr_read_b32 v79, a211
  v_accvgpr_read_b32 v80, a212
  v_accvgpr_read_b32 v81, a213
  v_accvgpr_read_b32 v82, a214
  v_accvgpr_read_b32 v83, a215
  v_lshlrev_b32 v52, 16, v64
  v_and_b32 v53, 0xffff0000, v64
  v_pk_mul_f32 v[44:45], v[20:21], v[52:53] op_sel_hi:[0,1]
  v_lshlrev_b32 v52, 16, v65
  v_and_b32 v53, 0xffff0000, v65
  v_pk_mul_f32 v[46:47], v[20:21], v[52:53] op_sel_hi:[0,1]
  buffer_load_dwordx4 a[0:3], v2, s[32:35], s88 offen offset:0 sc1
  v_lshlrev_b32 v52, 16, v66
  v_and_b32 v53, 0xffff0000, v66
  v_pk_mul_f32 v[48:49], v[20:21], v[52:53] op_sel_hi:[0,1]
  v_lshlrev_b32 v52, 16, v67
  v_and_b32 v53, 0xffff0000, v67
  v_pk_mul_f32 v[50:51], v[20:21], v[52:53] op_sel_hi:[0,1]
  buffer_load_dwordx4 a[4:7], v2, s[32:35], s88 offen offset:1024 sc1
  v_lshlrev_b32 v52, 16, v68
  v_and_b32 v53, 0xffff0000, v68
  v_pk_fma_f32 v[44:45], v[20:21], v[52:53], v[44:45] op_sel:[1,0,0]
  v_lshlrev_b32 v52, 16, v69
  v_and_b32 v53, 0xffff0000, v69
  v_pk_fma_f32 v[46:47], v[20:21], v[52:53], v[46:47] op_sel:[1,0,0]
  buffer_load_dwordx4 a[8:11], v2, s[32:35], s88 offen offset:2048 sc1
  v_lshlrev_b32 v52, 16, v70
  v_and_b32 v53, 0xffff0000, v70
  v_pk_fma_f32 v[48:49], v[20:21], v[52:53], v[48:49] op_sel:[1,0,0]
  v_lshlrev_b32 v52, 16, v71
  v_and_b32 v53, 0xffff0000, v71
  v_pk_fma_f32 v[50:51], v[20:21], v[52:53], v[50:51] op_sel:[1,0,0]
  buffer_load_dwordx4 a[12:15], v2, s[32:35], s88 offen offset:3072 sc1
  v_lshlrev_b32 v52, 16, v72
  v_and_b32 v53, 0xffff0000, v72
  v_pk_fma_f32 v[44:45], v[22:23], v[52:53], v[44:45] op_sel_hi:[0,1,1]
  v_lshlrev_b32 v52, 16, v73
  v_and_b32 v53, 0xffff0000, v73
  v_pk_fma_f32 v[46:47], v[22:23], v[52:53], v[46:47] op_sel_hi:[0,1,1]
  s_add_u32 s88, s88, 4096
  buffer_load_dwordx4 a[16:19], v2, s[32:35], s88 offen offset:0 sc1
  v_lshlrev_b32 v52, 16, v74
  v_and_b32 v53, 0xffff0000, v74
  v_pk_fma_f32 v[48:49], v[22:23], v[52:53], v[48:49] op_sel_hi:[0,1,1]
  v_lshlrev_b32 v52, 16, v75
  v_and_b32 v53, 0xffff0000, v75
  v_pk_fma_f32 v[50:51], v[22:23], v[52:53], v[50:51] op_sel_hi:[0,1,1]
  s_add_u32 s88, s88, 11264
  buffer_load_dwordx4 a[20:23], v2, s[32:35], s88 offen offset:0 sc1
  v_lshlrev_b32 v52, 16, v76
  v_and_b32 v53, 0xffff0000, v76
  v_pk_fma_f32 v[44:45], v[22:23], v[52:53], v[44:45] op_sel:[1,0,0]
  v_lshlrev_b32 v52, 16, v77
  v_and_b32 v53, 0xffff0000, v77
  v_pk_fma_f32 v[46:47], v[22:23], v[52:53], v[46:47] op_sel:[1,0,0]
  buffer_load_dwordx4 a[24:27], v2, s[32:35], s88 offen offset:1024 sc1
  v_lshlrev_b32 v52, 16, v78
  v_and_b32 v53, 0xffff0000, v78
  v_pk_fma_f32 v[48:49], v[22:23], v[52:53], v[48:49] op_sel:[1,0,0]
  v_lshlrev_b32 v52, 16, v79
  v_and_b32 v53, 0xffff0000, v79
  v_pk_fma_f32 v[50:51], v[22:23], v[52:53], v[50:51] op_sel:[1,0,0]
  buffer_load_dwordx4 a[28:31], v2, s[32:35], s88 offen offset:2048 sc1
  v_lshlrev_b32 v52, 16, v80
  v_and_b32 v53, 0xffff0000, v80
  v_pk_fma_f32 v[44:45], v[24:25], v[52:53], v[44:45] op_sel_hi:[0,1,1]
  v_lshlrev_b32 v52, 16, v81
  v_and_b32 v53, 0xffff0000, v81
  v_pk_fma_f32 v[46:47], v[24:25], v[52:53], v[46:47] op_sel_hi:[0,1,1]
  v_lshlrev_b32 v52, 16, v82
  v_and_b32 v53, 0xffff0000, v82
  v_pk_fma_f32 v[48:49], v[24:25], v[52:53], v[48:49] op_sel_hi:[0,1,1]
  v_lshlrev_b32 v52, 16, v83
  v_and_b32 v53, 0xffff0000, v83
  v_pk_fma_f32 v[50:51], v[24:25], v[52:53], v[50:51] op_sel_hi:[0,1,1]
  v_permlane32_swap_b32 v44, v48
  v_permlane32_swap_b32 v45, v49
  v_permlane32_swap_b32 v46, v50
  v_permlane32_swap_b32 v47, v51
  v_pk_add_f32 v[44:45], v[44:45], v[48:49]
  v_pk_add_f32 v[46:47], v[46:47], v[50:51]
  s_nop 1
  v_permlane16_swap_b32 v44, v46
  v_permlane16_swap_b32 v45, v47
  v_pk_add_f32 v[44:45], v[44:45], v[46:47]
  s_nop 1
  v_add_f32_dpp v46, v44, v44 row_ror:8 row_mask:0xf bank_mask:0xf
  v_add_f32_dpp v47, v45, v45 row_ror:8 row_mask:0xf bank_mask:0xf
  ds_write_b64 v16, v[46:47]
  v_lshlrev_b32 v52, 3, v1
  v_mov_b32 v49, s4
  s_waitcnt lgkmcnt(0)
  s_barrier
  ds_read2st64_b32 v[44:45], v17 offset0:0 offset1:1
  ds_read2st64_b32 v[46:47], v17 offset0:2 offset1:3
  s_waitcnt lgkmcnt(0)
  v_add_f32 v44, v44, v45
  v_add_f32 v46, v46, v47
  v_add_f32 v48, v44, v46
  s_mov_b64 exec, s[94:95]
  buffer_store_dwordx2 v[48:49], v52, s[32:35], s61 offen sc1
  s_mov_b64 exec, -1
  s_branch MODD_44
NOMOD_43:
  buffer_load_dwordx4 a[0:3], v2, s[32:35], s88 offen offset:0 sc1
  buffer_load_dwordx4 a[4:7], v2, s[32:35], s88 offen offset:1024 sc1
  buffer_load_dwordx4 a[8:11], v2, s[32:35], s88 offen offset:2048 sc1
  buffer_load_dwordx4 a[12:15], v2, s[32:35], s88 offen offset:3072 sc1
  s_add_u32 s88, s88, 4096
  buffer_load_dwordx4 a[16:19], v2, s[32:35], s88 offen offset:0 sc1
  s_add_u32 s88, s88, 11264
  buffer_load_dwordx4 a[20:23], v2, s[32:35], s88 offen offset:0 sc1
  buffer_load_dwordx4 a[24:27], v2, s[32:35], s88 offen offset:1024 sc1
  buffer_load_dwordx4 a[28:31], v2, s[32:35], s88 offen offset:2048 sc1
MODD_44:
  buffer_load_dword v159, v14, s[32:35], s78 offen sc1
  s_waitcnt vmcnt(9)
  s_mov_b64 exec, 1
  buffer_store_dword v235, v2, s[32:35], s86 offen offset:0 sc1
  s_mov_b64 exec, -1
  buffer_load_dwordx4 a[32:35], v2, s[32:35], s88 offen offset:3072 sc1
  s_lshl_b32 s5, s67, 11
  s_add_u32 s80, s89, s5
  s_add_u32 s80, s80, 8388608
  s_lshl_b32 s5, s67, 9
  s_add_u32 s81, s89, s5
  s_add_u32 s81, s81, 8404992
  s_lshl_b32 s5, s66, 3
  s_add_u32 s5, s5, s67
  s_lshl_b32 s5, s5, 2
  s_add_u32 s5, s5, s3
  s_lshl_b32 s5, s5, 7
  s_add_u32 s82, s5, 1048576
  s_lshl_b32 s5, s66, 2
  s_add_u32 s5, s5, s3
  s_lshl_b32 s5, s5, 11
  s_add_u32 s88, s88, 4096
  buffer_load_dwordx4 a[36:39], v2, s[32:35], s88 offen offset:0 sc1
  s_add_u32 s90, s5, 262144
  s_lshl_b32 s5, s67, 8
  s_add_u32 s91, s90, s5
  v_lshlrev_b32 v156, 7, v5
  v_lshl_add_u32 v156, v6, 4, v156
  v_mov_b32 v158, v191
  s_min_u32 s5, s3, 2
  s_mul_i32 s6, s5, 320
  s_add_u32 s6, s6, 161792
  v_lshrrev_b32 v157, 1, v191
  v_add_u32 v157, s6, v157
  s_add_u32 s5, s5, 1
  s_mul_i32 s5, s5, 5120
  s_add_u32 s79, s62, s5
  s_mul_i32 s5, s65, 3
  s_add_u32 s88, s88, 11264
  buffer_load_dwordx4 a[40:43], v2, s[32:35], s88 offen offset:0 sc1
  s_lshr_b32 s5, s5, 1
  s_lshl_b32 s5, s5, 6
  s_add_u32 s5, s5, s3
  s_lshl_b32 s5, s5, 7
  s_add_u32 s84, s5, 1179648
  v_min_u32 v228, 19, v1
  v_lshlrev_b32 v230, 9, v228
  v_add_u32 v231, 3072, v230
  v_cmp_gt_u32 vcc, 10, v228
  s_nop 1
  v_cndmask_b32 v228, v231, v230, vcc
  v_accvgpr_read_b32 v137, a240
  v_lshlrev_b32 v136, 16, v137
  v_and_b32 v137, 0xffff0000, v137
  v_accvgpr_read_b32 v139, a241
  v_lshlrev_b32 v138, 16, v139
  buffer_load_dwordx4 a[44:47], v2, s[32:35], s88 offen offset:1024 sc1
  v_and_b32 v139, 0xffff0000, v139
  v_accvgpr_read_b32 v141, a242
  v_lshlrev_b32 v140, 16, v141
  v_and_b32 v141, 0xffff0000, v141
  v_accvgpr_read_b32 v143, a243
  v_lshlrev_b32 v142, 16, v143
  v_and_b32 v143, 0xffff0000, v143
  v_accvgpr_read_b32 v145, a244
  v_lshlrev_b32 v144, 16, v145
  v_and_b32 v145, 0xffff0000, v145
  v_accvgpr_read_b32 v147, a245
  v_lshlrev_b32 v146, 16, v147
  v_and_b32 v147, 0xffff0000, v147
  v_accvgpr_read_b32 v149, a246
  v_lshlrev_b32 v148, 16, v149
  buffer_load_dwordx4 a[48:51], v2, s[32:35], s88 offen offset:2048 sc1
  v_and_b32 v149, 0xffff0000, v149
  v_accvgpr_read_b32 v151, a247
  v_lshlrev_b32 v150, 16, v151
  v_and_b32 v151, 0xffff0000, v151
  v_accvgpr_read_b32 v153, a248
  v_lshlrev_b32 v152, 16, v153
  v_and_b32 v153, 0xffff0000, v153
  v_accvgpr_read_b32 v155, a249
  v_lshlrev_b32 v154, 16, v155
  v_and_b32 v155, 0xffff0000, v155
  s_add_u32 s5, s3, 1
  s_and_b32 s5, s5, 3
  s_mul_i32 s5, s5, 15360
  s_add_u32 s5, s5, 81920
  v_add_u32 v8, s5, v2
  s_add_u32 s5, s3, 2
  s_and_b32 s5, s5, 3
  s_mul_i32 s5, s5, 15360
  s_add_u32 s5, s5, 87040
  v_add_u32 v9, s5, v2
  s_add_u32 s5, s3, 3
  s_and_b32 s5, s5, 3
  s_mul_i32 s5, s5, 15360
  s_add_u32 s5, s5, 92160
  v_add_u32 v10, s5, v2
  s_mul_i32 s5, s3, 15360
  s_add_u32 s5, s5, 81920
  v_add_u32 v11, s5, v2
  s_mov_b32 s6, 161792
  v_lshl_add_u32 v12, v5, 5, s6
  v_lshl_add_u32 v13, v5, 4, s6
  ds_read_b128 v[116:119], v12 offset:960
  ds_read_b128 v[120:123], v12 offset:976
  ds_read_b128 v[124:127], v12 offset:1088
  ds_read_b128 v[128:131], v12 offset:1104
  ds_read_b128 v[132:135], v13 offset:1216
  s_waitcnt vmcnt(6)
  v_cmp_ne_u32 vcc, s4, v159
  s_cbranch_vccz FOK_45
  s_mov_b64 exec, vcc
  s_movk_i32 s5, 0
POLL_46:
  buffer_load_dword v159, v14, s[32:35], s78 offen sc1
  s_addk_i32 s5, 1
  s_waitcnt vmcnt(0)
  v_cmp_ne_u32 vcc, s4, v159
  s_cmpk_ge_u32 s5, 20000
  s_cbranch_scc1 POLLX_47
  s_cbranch_vccz POLLX_47
  s_mov_b64 exec, vcc
  s_sleep 2
  s_branch POLL_46
POLLX_47:
  s_mov_b64 exec, -1
FOK_45:
  buffer_load_dwordx4 a[196:199], v2, s[32:35], s68 offen offset:0 sc1
  buffer_load_dwordx4 a[200:203], v2, s[32:35], s68 offen offset:1024 sc1
  buffer_load_dwordx4 a[204:207], v2, s[32:35], s68 offen offset:2048 sc1
  buffer_load_dwordx4 a[208:211], v2, s[32:35], s68 offen offset:3072 sc1
  buffer_load_dwordx4 a[212:215], v2, s[32:35], s72 offen sc1
  buffer_load_dwordx4 a[216:219], v2, s[32:35], s69 offen offset:0 sc1
  buffer_load_dwordx4 a[220:223], v2, s[32:35], s69 offen offset:1024 sc1
  buffer_load_dwordx4 a[224:227], v2, s[32:35], s69 offen offset:2048 sc1
  s_waitcnt lgkmcnt(0)
  s_barrier
  s_waitcnt vmcnt(7)
  v_mfma_f32_16x16x32_bf16 v[16:19], a[96:99], a[196:199], 0
  buffer_load_dwordx4 a[228:231], v2, s[32:35], s69 offen offset:3072 sc1
  v_mfma_f32_16x16x32_bf16 v[20:23], a[100:103], a[196:199], 0
  v_mfma_f32_16x16x32_bf16 v[24:27], a[104:107], a[196:199], 0
  buffer_load_dwordx4 a[232:235], v2, s[32:35], s73 offen sc1
  v_mfma_f32_16x16x32_bf16 v[28:31], a[108:111], a[196:199], 0
  v_mfma_f32_16x16x32_bf16 v[32:35], a[112:115], a[196:199], 0
  s_waitcnt vmcnt(8)
  v_mfma_f32_16x16x32_bf16 v[16:19], a[116:119], a[200:203], v[16:19]
  buffer_load_dwordx4 a[236:239], v2, s[32:35], s70 offen offset:0 sc1
  v_mfma_f32_16x16x32_bf16 v[20:23], a[120:123], a[200:203], v[20:23]
  v_mfma_f32_16x16x32_bf16 v[24:27], a[124:127], a[200:203], v[24:27]
  buffer_load_dwordx4 a[240:243], v2, s[32:35], s70 offen offset:1024 sc1
  v_mfma_f32_16x16x32_bf16 v[28:31], a[128:131], a[200:203], v[28:31]
  v_mfma_f32_16x16x32_bf16 v[32:35], a[132:135], a[200:203], v[32:35]
  s_waitcnt vmcnt(9)
  v_mfma_f32_16x16x32_bf16 v[16:19], a[136:139], a[204:207], v[16:19]
  v_mfma_f32_16x16x32_bf16 v[20:23], a[140:143], a[204:207], v[20:23]
  v_mfma_f32_16x16x32_bf16 v[24:27], a[144:147], a[204:207], v[24:27]
  buffer_load_dwordx4 a[244:247], v2, s[32:35], s70 offen offset:2048 sc1
  v_mfma_f32_16x16x32_bf16 v[28:31], a[148:151], a[204:207], v[28:31]
  v_mfma_f32_16x16x32_bf16 v[32:35], a[152:155], a[204:207], v[32:35]
  s_waitcnt vmcnt(9)
  v_mfma_f32_16x16x32_bf16 v[16:19], a[156:159], a[208:211], v[16:19]
  v_mfma_f32_16x16x32_bf16 v[20:23], a[160:163], a[208:211], v[20:23]
  v_mfma_f32_16x16x32_bf16 v[24:27], a[164:167], a[208:211], v[24:27]
  buffer_load_dwordx4 a[248:251], v2, s[32:35], s70 offen offset:3072 sc1
  v_mfma_f32_16x16x32_bf16 v[28:31], a[168:171], a[208:211], v[28:31]
  v_mfma_f32_16x16x32_bf16 v[32:35], a[172:175], a[208:211], v[32:35]
  s_waitcnt vmcnt(9)
  v_mfma_f32_16x16x32_bf16 v[16:19], a[176:179], a[212:215], v[16:19]
  v_mfma_f32_16x16x32_bf16 v[20:23], a[180:183], a[212:215], v[20:23]
  v_mfma_f32_16x16x32_bf16 v[24:27], a[184:187], a[212:215], v[24:27]
  buffer_load_dwordx4 a[252:255], v2, s[32:35], s74 offen sc1
  v_mfma_f32_16x16x32_bf16 v[28:31], a[188:191], a[212:215], v[28:31]
  v_mfma_f32_16x16x32_bf16 v[32:35], a[192:195], a[212:215], v[32:35]
  s_waitcnt vmcnt(9)
  v_mfma_f32_16x16x32_bf16 v[36:39], a[96:99], a[216:219], 0
  v_mfma_f32_16x16x32_bf16 v[40:43], a[100:103], a[216:219], 0
  v_mfma_f32_16x16x32_bf16 v[44:47], a[104:107], a[216:219], 0
  buffer_load_dwordx4 a[196:199], v2, s[32:35], s71 offen offset:0 sc1
  v_mfma_f32_16x16x32_bf16 v[48:51], a[108:111], a[216:219], 0
  ds_write_b128 v8, v[16:19] offset:0
  v_mfma_f32_16x16x32_bf16 v[52:55], a[112:115], a[216:219], 0
  s_waitcnt vmcnt(9)
  v_mfma_f32_16x16x32_bf16 v[36:39], a[116:119], a[220:223], v[36:39]
  ds_write_b128 v8, v[20:23] offset:1024
  v_mfma_f32_16x16x32_bf16 v[40:43], a[120:123], a[220:223], v[40:43]
  v_mfma_f32_16x16x32_bf16 v[44:47], a[124:127], a[220:223], v[44:47]
  buffer_load_dwordx4 a[200:203], v2, s[32:35], s71 offen offset:1024 sc1
  v_mfma_f32_16x16x32_bf16 v[48:51], a[128:131], a[220:223], v[48:51]
  ds_write_b128 v8, v[24:27] offset:2048
  v_mfma_f32_16x16x32_bf16 v[52:55], a[132:135], a[220:223], v[52:55]
  s_waitcnt vmcnt(9)
  v_mfma_f32_16x16x32_bf16 v[36:39], a[136:139], a[224:227], v[36:39]
  ds_write_b128 v8, v[28:31] offset:3072
  v_mfma_f32_16x16x32_bf16 v[40:43], a[140:143], a[224:227], v[40:43]
  v_mfma_f32_16x16x32_bf16 v[44:47], a[144:147], a[224:227], v[44:47]
  buffer_load_dwordx4 a[204:207], v2, s[32:35], s71 offen offset:2048 sc1
  v_mfma_f32_16x16x32_bf16 v[48:51], a[148:151], a[224:227], v[48:51]
  ds_write_b128 v8, v[32:35] offset:4096
  v_mfma_f32_16x16x32_bf16 v[52:55], a[152:155], a[224:227], v[52:55]
  s_waitcnt vmcnt(9)
  v_mfma_f32_16x16x32_bf16 v[36:39], a[156:159], a[228:231], v[36:39]
  v_mfma_f32_16x16x32_bf16 v[40:43], a[160:163], a[228:231], v[40:43]
  v_mfma_f32_16x16x32_bf16 v[44:47], a[164:167], a[228:231], v[44:47]
  buffer_load_dwordx4 a[208:211], v2, s[32:35], s71 offen offset:3072 sc1
  v_mfma_f32_16x16x32_bf16 v[48:51], a[168:171], a[228:231], v[48:51]
  v_mfma_f32_16x16x32_bf16 v[52:55], a[172:175], a[228:231], v[52:55]
  s_waitcnt vmcnt(9)
  v_mfma_f32_16x16x32_bf16 v[36:39], a[176:179], a[232:235], v[36:39]
  v_mfma_f32_16x16x32_bf16 v[40:43], a[180:183], a[232:235], v[40:43]
  v_mfma_f32_16x16x32_bf16 v[44:47], a[184:187], a[232:235], v[44:47]
  buffer_load_dwordx4 a[212:215], v2, s[32:35], s75 offen sc1
  v_mfma_f32_16x16x32_bf16 v[48:51], a[188:191], a[232:235], v[48:51]
  v_mfma_f32_16x16x32_bf16 v[52:55], a[192:195], a[232:235], v[52:55]
  s_waitcnt vmcnt(9)
  v_mfma_f32_16x16x32_bf16 v[16:19], a[96:99], a[236:239], 0
  v_mfma_f32_16x16x32_bf16 v[20:23], a[100:103], a[236:239], 0
  v_mfma_f32_16x16x32_bf16 v[24:27], a[104:107], a[236:239], 0
  s_add_u32 s6, s79, 0
  buffer_load_dwordx4 v[208:211], v158, s[32:35], s6 offen sc1
  v_mfma_f32_16x16x32_bf16 v[28:31], a[108:111], a[236:239], 0
  ds_write_b128 v9, v[36:39] offset:0
  v_mfma_f32_16x16x32_bf16 v[32:35], a[112:115], a[236:239], 0
  s_waitcnt vmcnt(9)
  v_mfma_f32_16x16x32_bf16 v[16:19], a[116:119], a[240:243], v[16:19]
  ds_write_b128 v9, v[40:43] offset:1024
  v_mfma_f32_16x16x32_bf16 v[20:23], a[120:123], a[240:243], v[20:23]
  v_mfma_f32_16x16x32_bf16 v[24:27], a[124:127], a[240:243], v[24:27]
  s_add_u32 s6, s79, 30720
  buffer_load_dwordx4 v[212:215], v158, s[32:35], s6 offen sc1
  v_mfma_f32_16x16x32_bf16 v[28:31], a[128:131], a[240:243], v[28:31]
  ds_write_b128 v9, v[44:47] offset:2048
  v_mfma_f32_16x16x32_bf16 v[32:35], a[132:135], a[240:243], v[32:35]
  s_waitcnt vmcnt(9)
  v_mfma_f32_16x16x32_bf16 v[16:19], a[136:139], a[244:247], v[16:19]
  ds_write_b128 v9, v[48:51] offset:3072
  v_mfma_f32_16x16x32_bf16 v[20:23], a[140:143], a[244:247], v[20:23]
  v_mfma_f32_16x16x32_bf16 v[24:27], a[144:147], a[244:247], v[24:27]
  s_add_u32 s6, s79, 61440
  buffer_load_dwordx4 v[216:219], v158, s[32:35], s6 offen sc1
  v_mfma_f32_16x16x32_bf16 v[28:31], a[148:151], a[244:247], v[28:31]
  ds_write_b128 v9, v[52:55] offset:4096
  v_mfma_f32_16x16x32_bf16 v[32:35], a[152:155], a[244:247], v[32:35]
  s_waitcnt vmcnt(9)
  v_mfma_f32_16x16x32_bf16 v[16:19], a[156:159], a[248:251], v[16:19]
  v_mfma_f32_16x16x32_bf16 v[20:23], a[160:163], a[248:251], v[20:23]
  v_mfma_f32_16x16x32_bf16 v[24:27], a[164:167], a[248:251], v[24:27]
  s_add_u32 s6, s79, 92160
  buffer_load_dwordx4 v[220:223], v158, s[32:35], s6 offen sc1
  v_mfma_f32_16x16x32_bf16 v[28:31], a[168:171], a[248:251], v[28:31]
  v_mfma_f32_16x16x32_bf16 v[32:35], a[172:175], a[248:251], v[32:35]
  s_waitcnt vmcnt(9)
  v_mfma_f32_16x16x32_bf16 v[16:19], a[176:179], a[252:255], v[16:19]
  v_mfma_f32_16x16x32_bf16 v[20:23], a[180:183], a[252:255], v[20:23]
  v_mfma_f32_16x16x32_bf16 v[24:27], a[184:187], a[252:255], v[24:27]
  buffer_load_dwordx4 a[52:55], v2, s[32:35], s88 offen offset:3072 sc1
  v_mfma_f32_16x16x32_bf16 v[28:31], a[188:191], a[252:255], v[28:31]
  v_mfma_f32_16x16x32_bf16 v[32:35], a[192:195], a[252:255], v[32:35]
  s_waitcnt vmcnt(9)
  v_mfma_f32_16x16x32_bf16 v[36:39], a[96:99], a[196:199], 0
  v_mfma_f32_16x16x32_bf16 v[40:43], a[100:103], a[196:199], 0
  v_mfma_f32_16x16x32_bf16 v[44:47], a[104:107], a[196:199], 0
  s_add_u32 s88, s88, 4096
  buffer_load_dwordx4 a[56:59], v2, s[32:35], s88 offen offset:0 sc1
  v_mfma_f32_16x16x32_bf16 v[48:51], a[108:111], a[196:199], 0
  ds_write_b128 v10, v[16:19] offset:0
  v_mfma_f32_16x16x32_bf16 v[52:55], a[112:115], a[196:199], 0
  buffer_load_dword v230, v228, s[32:35], s84 offen sc1
  s_waitcnt vmcnt(10)
  v_mfma_f32_16x16x32_bf16 v[36:39], a[116:119], a[200:203], v[36:39]
  ds_write_b128 v10, v[20:23] offset:1024
  v_mfma_f32_16x16x32_bf16 v[40:43], a[120:123], a[200:203], v[40:43]
  v_mfma_f32_16x16x32_bf16 v[44:47], a[124:127], a[200:203], v[44:47]
  s_add_u32 s88, s88, 11264
  buffer_load_dwordx4 a[60:63], v2, s[32:35], s88 offen offset:0 sc1
  v_mfma_f32_16x16x32_bf16 v[48:51], a[128:131], a[200:203], v[48:51]
  ds_write_b128 v10, v[24:27] offset:2048
  v_mfma_f32_16x16x32_bf16 v[52:55], a[132:135], a[200:203], v[52:55]
  s_waitcnt vmcnt(10)
  v_mfma_f32_16x16x32_bf16 v[36:39], a[136:139], a[204:207], v[36:39]
  ds_write_b128 v10, v[28:31] offset:3072
  v_mfma_f32_16x16x32_bf16 v[40:43], a[140:143], a[204:207], v[40:43]
  v_mfma_f32_16x16x32_bf16 v[44:47], a[144:147], a[204:207], v[44:47]
  buffer_load_dwordx4 a[64:67], v2, s[32:35], s88 offen offset:1024 sc1
  v_mfma_f32_16x16x32_bf16 v[48:51], a[148:151], a[204:207], v[48:51]
  ds_write_b128 v10, v[32:35] offset:4096
  v_mfma_f32_16x16x32_bf16 v[52:55], a[152:155], a[204:207], v[52:55]
  s_waitcnt vmcnt(10)
  v_mfma_f32_16x16x32_bf16 v[36:39], a[156:159], a[208:211], v[36:39]
  v_mfma_f32_16x16x32_bf16 v[40:43], a[160:163], a[208:211], v[40:43]
  s_waitcnt lgkmcnt(0)
  s_barrier
  v_mfma_f32_16x16x32_bf16 v[44:47], a[164:167], a[208:211], v[44:47]
  buffer_load_dwordx4 a[68:71], v2, s[32:35], s88 offen offset:2048 sc1
  v_mfma_f32_16x16x32_bf16 v[48:51], a[168:171], a[208:211], v[48:51]
  ds_read_b128 v[56:59], v11 offset:0
  ds_read_b128 v[60:63], v11 offset:1024
  v_mfma_f32_16x16x32_bf16 v[52:55], a[172:175], a[208:211], v[52:55]
  ds_read_b128 v[64:67], v11 offset:2048
  ds_read_b128 v[68:71], v11 offset:3072
  s_waitcnt vmcnt(10)
  v_mfma_f32_16x16x32_bf16 v[36:39], a[176:179], a[212:215], v[36:39]
  ds_read_b128 v[72:75], v11 offset:4096
  ds_read_b128 v[76:79], v11 offset:5120
  v_mfma_f32_16x16x32_bf16 v[40:43], a[180:183], a[212:215], v[40:43]
  ds_read_b128 v[80:83], v11 offset:6144
  ds_read_b128 v[84:87], v11 offset:7168
  v_mfma_f32_16x16x32_bf16 v[44:47], a[184:187], a[212:215], v[44:47]
  buffer_load_dwordx4 a[72:75], v2, s[32:35], s88 offen offset:3072 sc1
  v_mfma_f32_16x16x32_bf16 v[48:51], a[188:191], a[212:215], v[48:51]
  ds_read_b128 v[88:91], v11 offset:8192
  ds_read_b128 v[92:95], v11 offset:9216
  v_mfma_f32_16x16x32_bf16 v[52:55], a[192:195], a[212:215], v[52:55]
  ds_read_b128 v[96:99], v11 offset:10240
  ds_read_b128 v[100:103], v11 offset:11264
  ds_read_b128 v[104:107], v11 offset:12288
  ds_read_b128 v[108:111], v11 offset:13312
  ds_read_b128 v[112:115], v11 offset:14336
  s_waitcnt lgkmcnt(5)
  v_pk_add_f32 v[56:57], v[56:57], v[76:77]
  v_pk_add_f32 v[58:59], v[58:59], v[78:79]
  v_pk_add_f32 v[60:61], v[60:61], v[80:81]
  v_pk_add_f32 v[62:63], v[62:63], v[82:83]
  v_pk_add_f32 v[64:65], v[64:65], v[84:85]
  v_pk_add_f32 v[66:67], v[66:67], v[86:87]
  v_pk_add_f32 v[68:69], v[68:69], v[88:89]
  v_pk_add_f32 v[70:71], v[70:71], v[90:91]
  v_pk_add_f32 v[72:73], v[72:73], v[92:93]
  v_pk_add_f32 v[74:75], v[74:75], v[94:95]
  s_waitcnt lgkmcnt(0)
  v_pk_add_f32 v[56:57], v[56:57], v[96:97]
  v_pk_add_f32 v[58:59], v[58:59], v[98:99]
  v_pk_add_f32 v[60:61], v[60:61], v[100:101]
  v_pk_add_f32 v[62:63], v[62:63], v[102:103]
  v_pk_add_f32 v[64:65], v[64:65], v[104:105]
  v_pk_add_f32 v[66:67], v[66:67], v[106:107]
  v_pk_add_f32 v[68:69], v[68:69], v[108:109]
  v_pk_add_f32 v[70:71], v[70:71], v[110:111]
  v_pk_add_f32 v[72:73], v[72:73], v[112:113]
  v_pk_add_f32 v[74:75], v[74:75], v[114:115]
  v_pk_fma_f32 v[56:57], v[56:57], v[116:117], v[136:137]
  v_pk_fma_f32 v[58:59], v[58:59], v[118:119], v[138:139]
  v_pk_fma_f32 v[60:61], v[60:61], v[120:121], v[140:141]
  v_pk_fma_f32 v[62:63], v[62:63], v[122:123], v[142:143]
  v_pk_fma_f32 v[64:65], v[64:65], v[124:125], v[144:145]
  v_pk_fma_f32 v[66:67], v[66:67], v[126:127], v[146:147]
  v_pk_fma_f32 v[68:69], v[68:69], v[128:129], v[148:149]
  v_pk_fma_f32 v[70:71], v[70:71], v[130:131], v[150:151]
  v_pk_fma_f32 v[72:73], v[72:73], v[132:133], v[152:153]
  v_pk_fma_f32 v[74:75], v[74:75], v[134:135], v[154:155]
  v_pk_fma_f32 v[36:37], v[36:37], v[116:117], v[56:57]
  v_pk_fma_f32 v[38:39], v[38:39], v[118:119], v[58:59]
  v_pk_fma_f32 v[40:41], v[40:41], v[120:121], v[60:61]
  v_pk_fma_f32 v[42:43], v[42:43], v[122:123], v[62:63]
  v_pk_fma_f32 v[44:45], v[44:45], v[124:125], v[64:65]
  v_pk_fma_f32 v[46:47], v[46:47], v[126:127], v[66:67]
  v_pk_fma_f32 v[48:49], v[48:49], v[128:129], v[68:69]
  v_pk_fma_f32 v[50:51], v[50:51], v[130:131], v[70:71]
  v_pk_fma_f32 v[52:53], v[52:53], v[132:133], v[72:73]
  v_pk_fma_f32 v[54:55], v[54:55], v[134:135], v[74:75]
  v_cvt_pk_bf16_f32 v236, v36, v37
  v_cvt_pk_bf16_f32 v237, v38, v39
  v_cvt_pk_bf16_f32 v238, v40, v41
  v_cvt_pk_bf16_f32 v239, v42, v43
  v_cvt_pk_bf16_f32 v240, v44, v45
  v_cvt_pk_bf16_f32 v241, v46, v47
  v_cvt_pk_bf16_f32 v242, v48, v49
  v_cvt_pk_bf16_f32 v243, v50, v51
  v_cvt_pk_bf16_f32 v244, v52, v53
  v_cvt_pk_bf16_f32 v245, v54, v55
  s_mov_b32 s5, 0x3f803f80
  v_dot2_f32_bf16 v56, v236, s5, 0
  v_dot2_f32_bf16 v58, v236, v236, 0
  v_dot2_f32_bf16 v57, v237, s5, 0
  v_dot2_f32_bf16 v59, v237, v237, 0
  v_dot2_f32_bf16 v56, v238, s5, v56
  v_dot2_f32_bf16 v58, v238, v238, v58
  v_dot2_f32_bf16 v57, v239, s5, v57
  v_dot2_f32_bf16 v59, v239, v239, v59
  v_dot2_f32_bf16 v56, v240, s5, v56
  v_dot2_f32_bf16 v58, v240, v240, v58
  v_dot2_f32_bf16 v57, v241, s5, v57
  v_dot2_f32_bf16 v59, v241, v241, v59
  v_dot2_f32_bf16 v56, v242, s5, v56
  v_dot2_f32_bf16 v58, v242, v242, v58
  v_dot2_f32_bf16 v57, v243, s5, v57
  v_dot2_f32_bf16 v59, v243, v243, v59
  v_dot2_f32_bf16 v56, v244, s5, v56
  v_dot2_f32_bf16 v58, v244, v244, v58
  v_dot2_f32_bf16 v57, v245, s5, v57
  v_dot2_f32_bf16 v59, v245, v245, v59
  v_mov_b32 v225, s4
  v_mov_b32 v227, s4
  v_add_f32 v224, v56, v57
  v_add_f32 v226, v58, v59
  v_mov_b32 v60, v224
  v_mov_b32 v61, v226
  s_nop 0
  v_permlane32_swap_b32 v224, v60
  v_permlane32_swap_b32 v226, v61
  v_add_f32 v224, v224, v60
  v_add_f32 v226, v226, v61
  v_mov_b32 v60, v224
  v_mov_b32 v61, v226
  s_nop 0
  v_permlane16_swap_b32 v224, v60
  v_permlane16_swap_b32 v226, v61
  v_add_f32 v224, v224, v60
  v_add_f32 v226, v226, v61
  s_mov_b64 exec, 0xffff
  buffer_store_dwordx4 v[224:227], v2, s[32:35], s91 offen sc1
  s_mov_b64 exec, -1
  s_waitcnt vmcnt(8)
  s_waitcnt vmcnt(5)
  v_cmp_ne_u32 vcc, s4, v230
  s_cbranch_vccz FOK_48
  s_mov_b64 exec, vcc
  s_movk_i32 s5, 0
POLL_49:
  buffer_load_dword v230, v228, s[32:35], s84 offen sc1
  s_addk_i32 s5, 1
  s_waitcnt vmcnt(0)
  v_cmp_ne_u32 vcc, s4, v230
  s_cmpk_ge_u32 s5, 20000
  s_cbranch_scc1 POLLX_50
  s_cbranch_vccz POLLX_50
  s_mov_b64 exec, vcc
  s_sleep 8
  s_branch POLL_49
POLLX_50:
  s_mov_b64 exec, -1
FOK_48:
  s_add_u32 m0, s93, 0
  s_mul_i32 s83, s65, 245760
  s_add_u32 s83, s83, s93
  s_add_u32 s83, s83, 19922944
  buffer_load_dwordx4 v2, s[32:35], s83 offen offset:0 sc1 lds
  buffer_load_dwordx4 v2, s[32:35], s83 offen offset:1024 sc1 lds
  buffer_load_dwordx4 v2, s[32:35], s83 offen offset:2048 sc1 lds
  buffer_load_dwordx4 v2, s[32:35], s83 offen offset:3072 sc1 lds
  s_add_u32 m0, m0, 16384
  s_add_u32 s83, s83, 16384
  buffer_load_dwordx4 v2, s[32:35], s83 offen offset:0 sc1 lds
  buffer_load_dwordx4 v2, s[32:35], s83 offen offset:1024 sc1 lds
  s_movk_i32 s5, 0
TC_51:
  v_mov_b32 v60, 0
  v_xor_b32 v61, s4, v209
  v_xor_b32 v62, s4, v211
  v_or3_b32 v60, v60, v61, v62
  v_xor_b32 v61, s4, v213
  v_xor_b32 v62, s4, v215
  v_or3_b32 v60, v60, v61, v62
  v_xor_b32 v61, s4, v217
  v_xor_b32 v62, s4, v219
  v_or3_b32 v60, v60, v61, v62
  v_xor_b32 v61, s4, v221
  v_xor_b32 v62, s4, v223
  v_or3_b32 v60, v60, v61, v62
  v_cmp_ne_u32 vcc, 0, v60
  s_addk_i32 s5, 1
  s_cbranch_vccz TOK_52
  s_cmpk_ge_u32 s5, 20000
  s_cbranch_scc1 TOK_52
  s_sleep 2
  s_add_u32 s6, s79, 0
  buffer_load_dwordx4 v[208:211], v158, s[32:35], s6 offen sc1
  s_add_u32 s6, s79, 30720
  buffer_load_dwordx4 v[212:215], v158, s[32:35], s6 offen sc1
  s_add_u32 s6, s79, 61440
  buffer_load_dwordx4 v[216:219], v158, s[32:35], s6 offen sc1
  s_add_u32 s6, s79, 92160
  buffer_load_dwordx4 v[220:223], v158, s[32:35], s6 offen sc1
  s_waitcnt vmcnt(0)
  s_branch TC_51
TOK_52:
  s_cmp_eq_u32 s3, 1
  s_cselect_b32 s7, 1.0, 0
  v_add_f32 v208, v208, v212
  v_add_f32 v210, v210, v214
  v_add_f32 v216, v216, v220
  v_add_f32 v218, v218, v222
  v_add_f32 v208, v208, v216
  v_add_f32 v210, v210, v218
  v_cvt_pk_bf16_f32 v212, v208, v210
  v_lshlrev_b32 v208, 16, v212
  v_and_b32 v209, 0xffff0000, v212
  v_add_f32 v208, s7, v208
  v_add_f32 v209, s7, v209
  v_cvt_pk_bf16_f32 v212, v208, v209
  v_lshlrev_b32 v208, 16, v212
  v_and_b32 v209, 0xffff0000, v212
  ds_write_b64 v157, v[208:209]
  v_lshlrev_b32 v36, 16, v236
  v_and_b32 v37, 0xffff0000, v236
  v_lshlrev_b32 v38, 16, v237
  v_and_b32 v39, 0xffff0000, v237
  v_lshlrev_b32 v40, 16, v238
  v_and_b32 v41, 0xffff0000, v238
  v_lshlrev_b32 v42, 16, v239
  v_and_b32 v43, 0xffff0000, v239
  v_lshlrev_b32 v44, 16, v240
  v_and_b32 v45, 0xffff0000, v240
  v_lshlrev_b32 v46, 16, v241
  v_and_b32 v47, 0xffff0000, v241
  v_lshlrev_b32 v48, 16, v242
  v_and_b32 v49, 0xffff0000, v242
  v_lshlrev_b32 v50, 16, v243
  v_and_b32 v51, 0xffff0000, v243
  v_lshlrev_b32 v52, 16, v244
  v_and_b32 v53, 0xffff0000, v244
  v_lshlrev_b32 v54, 16, v245
  v_and_b32 v55, 0xffff0000, v245
  s_waitcnt lgkmcnt(0)
  s_barrier
  ds_read_b128 v[76:79], v12 offset:0
  ds_read_b128 v[80:83], v12 offset:16
  ds_read_b128 v[84:87], v12 offset:128
  ds_read_b128 v[88:91], v12 offset:144
  ds_read_b128 v[92:95], v13 offset:256
  ds_read_b128 v[96:99], v12 offset:320
  ds_read_b128 v[100:103], v12 offset:336
  ds_read_b128 v[104:107], v12 offset:448
  ds_read_b128 v[108:111], v12 offset:464
  ds_read_b128 v[112:115], v13 offset:576
  ds_read_b128 v[116:119], v12 offset:640
  ds_read_b128 v[120:123], v12 offset:656
  ds_read_b128 v[124:127], v12 offset:768
  ds_read_b128 v[128:131], v12 offset:784
  ds_read_b128 v[132:135], v13 offset:896
  s_movk_i32 s5, 0
SG_53:
  buffer_load_dwordx4 v[24:27], v2, s[32:35], s90 offen sc1
  buffer_load_dwordx4 v[28:31], v2, s[32:35], s90 offen offset:1024 sc1
  s_addk_i32 s5, 1
  s_waitcnt vmcnt(0)
  v_xor_b32 v20, s4, v25
  v_xor_b32 v21, s4, v27
  v_xor_b32 v22, s4, v29
  v_xor_b32 v23, s4, v31
  v_or3_b32 v20, v20, v21, v22
  v_or_b32 v20, v20, v23
  v_cmp_ne_u32 vcc, 0, v20
  s_cmpk_ge_u32 s5, 20000
  s_cbranch_scc1 SGX_54
  s_cbranch_vccnz SG_53
SGX_54:
  v_add_f32 v16, v24, v28
  v_add_f32 v18, v26, v30
  buffer_load_dwordx4 v2, s[32:35], s83 offen offset:2048 sc1 lds
  v_mov_b32 v20, v16
  v_mov_b32 v21, v18
  s_nop 0
  v_permlane32_swap_b32 v16, v20
  v_permlane32_swap_b32 v18, v21
  v_add_f32 v16, v16, v20
  v_add_f32 v18, v18, v21
  v_mov_b32 v20, v16
  v_mov_b32 v21, v18
  s_nop 0
  v_permlane16_swap_b32 v16, v20
  v_permlane16_swap_b32 v18, v21
  v_add_f32 v16, v16, v20
  v_add_f32 v18, v18, v21
  v_mul_f32 v20, 0x3acccccd, v16
  v_mul_f32 v18, 0x3acccccd, v18
  v_fma_f32 v18, -v20, v20, v18
  v_max_f32 v18, 0, v18
  v_add_f32 v18, 0x3727c5ac, v18
  v_rsq_f32 v16, v18
  s_nop 0
  v_mul_f32_e64 v18, -v20, v16
  buffer_load_dwordx4 v2, s[32:35], s83 offen offset:3072 sc1 lds
  s_waitcnt lgkmcnt(0)
  v_pk_fma_f32 v[36:37], v[36:37], v[16:17], v[18:19] op_sel_hi:[1,0,0]
  v_pk_fma_f32 v[38:39], v[38:39], v[16:17], v[18:19] op_sel_hi:[1,0,0]
  v_pk_fma_f32 v[40:41], v[40:41], v[16:17], v[18:19] op_sel_hi:[1,0,0]
  v_pk_fma_f32 v[42:43], v[42:43], v[16:17], v[18:19] op_sel_hi:[1,0,0]
  v_pk_fma_f32 v[36:37], v[36:37], v[96:97], v[76:77]
  v_pk_fma_f32 v[38:39], v[38:39], v[98:99], v[78:79]
  v_pk_fma_f32 v[40:41], v[40:41], v[100:101], v[80:81]
  v_pk_fma_f32 v[42:43], v[42:43], v[102:103], v[82:83]
  v_cvt_pk_bf16_f32 v56, v36, v37
  v_cvt_pk_bf16_f32 v57, v38, v39
  v_cvt_pk_bf16_f32 v58, v40, v41
  v_cvt_pk_bf16_f32 v59, v42, v43
  buffer_store_dwordx4 v[56:59], v2, s[32:35], s80 offen offset:0 sc1
  v_pk_fma_f32 v[44:45], v[44:45], v[16:17], v[18:19] op_sel_hi:[1,0,0]
  v_pk_fma_f32 v[46:47], v[46:47], v[16:17], v[18:19] op_sel_hi:[1,0,0]
  v_pk_fma_f32 v[48:49], v[48:49], v[16:17], v[18:19] op_sel_hi:[1,0,0]
  v_pk_fma_f32 v[50:51], v[50:51], v[16:17], v[18:19] op_sel_hi:[1,0,0]
  v_pk_fma_f32 v[44:45], v[44:45], v[104:105], v[84:85]
  v_pk_fma_f32 v[46:47], v[46:47], v[106:107], v[86:87]
  v_pk_fma_f32 v[48:49], v[48:49], v[108:109], v[88:89]
  v_pk_fma_f32 v[50:51], v[50:51], v[110:111], v[90:91]
  v_cvt_pk_bf16_f32 v60, v44, v45
  v_cvt_pk_bf16_f32 v61, v46, v47
  v_cvt_pk_bf16_f32 v62, v48, v49
  v_cvt_pk_bf16_f32 v63, v50, v51
  buffer_store_dwordx4 v[60:63], v2, s[32:35], s80 offen offset:1024 sc1
  v_pk_fma_f32 v[52:53], v[52:53], v[16:17], v[18:19] op_sel_hi:[1,0,0]
  v_pk_fma_f32 v[54:55], v[54:55], v[16:17], v[18:19] op_sel_hi:[1,0,0]
  v_pk_fma_f32 v[52:53], v[52:53], v[112:113], v[92:93]
  v_pk_fma_f32 v[54:55], v[54:55], v[114:115], v[94:95]
  v_cvt_pk_bf16_f32 v64, v52, v53
  v_cvt_pk_bf16_f32 v65, v54, v55
  v_mov_b32 v66, v64
  v_mov_b32 v67, v65
  s_nop 0
  v_permlane16_swap_b32 v64, v66
  v_permlane16_swap_b32 v65, v67
  s_mov_b32 exec_lo, 0xffff
  s_mov_b32 exec_hi, 0xffff
  buffer_store_dwordx4 v[64:67], v156, s[32:35], s81 offen sc1
  s_mov_b64 exec, -1
  v_cvt_pk_bf16_f32 v246, v116, v117
  s_add_u32 m0, m0, 16384
  s_add_u32 s83, s83, 16384
  buffer_load_dwordx4 v2, s[32:35], s83 offen offset:0 sc1 lds
  v_cvt_pk_bf16_f32 v247, v118, v119
  buffer_load_dwordx4 v2, s[32:35], s83 offen offset:1024 sc1 lds
  v_cvt_pk_bf16_f32 v248, v120, v121
  buffer_load_dwordx4 v2, s[32:35], s83 offen offset:2048 sc1 lds
  v_cvt_pk_bf16_f32 v249, v122, v123
  buffer_load_dwordx4 v2, s[32:35], s83 offen offset:3072 sc1 lds
  v_cvt_pk_bf16_f32 v250, v124, v125
  s_add_u32 m0, m0, 16384
  s_add_u32 s83, s83, 16384
  buffer_load_dwordx4 v2, s[32:35], s83 offen offset:0 sc1 lds
  v_cvt_pk_bf16_f32 v251, v126, v127
  buffer_load_dwordx4 v2, s[32:35], s83 offen offset:1024 sc1 lds
  v_cvt_pk_bf16_f32 v252, v128, v129
  buffer_load_dwordx4 v2, s[32:35], s83 offen offset:2048 sc1 lds
  v_cvt_pk_bf16_f32 v253, v130, v131
  v_cvt_pk_bf16_f32 v254, v132, v133
  v_cvt_pk_bf16_f32 v255, v134, v135
  s_waitcnt vmcnt(7)
  s_mov_b64 exec, 1
  buffer_store_dword v235, v2, s[32:35], s82 offen offset:0 sc1
  s_mov_b64 exec, -1
  s_barrier
  buffer_load_dwordx4 v2, s[32:35], s83 offen offset:3072 sc1 lds
  s_add_u32 m0, m0, 16384
  s_add_u32 s83, s83, 16384
  buffer_load_dwordx4 v2, s[32:35], s83 offen offset:0 sc1 lds
  buffer_load_dwordx4 v2, s[32:35], s83 offen offset:1024 sc1 lds
  buffer_load_dwordx4 v2, s[32:35], s83 offen offset:2048 sc1 lds
  buffer_load_dwordx4 v2, s[32:35], s83 offen offset:3072 sc1 lds
  s_add_u32 m0, s93, 81920
  s_mul_i32 s83, s65, 245760
  s_add_u32 s83, s83, s93
  s_add_u32 s83, s83, 20004864
  buffer_load_dwordx4 v2, s[32:35], s83 offen offset:0 sc1 lds
  buffer_load_dwordx4 v2, s[32:35], s83 offen offset:1024 sc1 lds
  buffer_load_dwordx4 v2, s[32:35], s83 offen offset:2048 sc1 lds
  buffer_load_dwordx4 v2, s[32:35], s83 offen offset:3072 sc1 lds
  s_add_u32 m0, m0, 16384
  s_add_u32 s83, s83, 16384
  buffer_load_dwordx4 v2, s[32:35], s83 offen offset:0 sc1 lds
  buffer_load_dwordx4 v2, s[32:35], s83 offen offset:1024 sc1 lds
  buffer_load_dwordx4 v2, s[32:35], s83 offen offset:2048 sc1 lds
  buffer_load_dwordx4 v2, s[32:35], s83 offen offset:3072 sc1 lds
  v_min_u32 v11, 15, v1
  v_and_b32 v10, 7, v11
  v_lshrrev_b32 v11, 3, v11
  v_lshl_add_u32 v10, v10, 2, v11
  v_lshlrev_b32 v10, 7, v10
  s_lshl_b32 s5, s64, 1
  s_lshr_b32 s6, s3, 1
  s_add_u32 s5, s5, s6
  s_lshl_b32 s5, s5, 4
  s_and_b32 s6, s3, 1
  s_add_u32 s5, s5, s6
  s_lshl_b32 s5, s5, 8
  s_add_u32 s84, s5, 1048576
  buffer_load_dword v233, v10, s[32:35], s84 offen sc1
  s_add_u32 m0, m0, 16384
  s_add_u32 s83, s83, 16384
  buffer_load_dwordx4 v2, s[32:35], s83 offen offset:0 sc1 lds
  buffer_load_dwordx4 v2, s[32:35], s83 offen offset:1024 sc1 lds
  buffer_load_dwordx4 v2, s[32:35], s83 offen offset:2048 sc1 lds
  buffer_load_dwordx4 v2, s[32:35], s83 offen offset:3072 sc1 lds
  s_add_u32 m0, m0, 16384
  s_add_u32 s83, s83, 16384
  buffer_load_dwordx4 v2, s[32:35], s83 offen offset:0 sc1 lds
  buffer_load_dwordx4 v2, s[32:35], s83 offen offset:1024 sc1 lds
  s_getpc_b64 s[44:45]
L_pf2:
  s_mov_b32 s46, 13352
  s_mov_b32 s47, 0x20000
  s_lshr_b32 s5, s2, 3
  s_lshl_b32 s5, s5, 10
  v_min_u32 v234, 7, v1
  v_lshlrev_b32 v234, 7, v234
  s_cmp_lg_u32 s3, 1
  s_cbranch_scc1 PF_55
  buffer_load_dword v234, v234, s[44:47], s5 offen
PF_55:
  s_add_u32 s78, s76, 8388608
  s_add_u32 s79, s78, 20480
  s_lshl_b32 s5, s64, 3
  s_lshl_b32 s6, s3, 1
  s_add_u32 s6, s6, s5
  s_mul_i32 s80, s6, 49152
  s_mul_i32 s5, s65, 3072
  s_add_u32 s80, s80, s5
  s_add_u32 s80, s80, 29360128
  s_add_u32 s81, s80, 49152
  s_lshl_b32 s5, s64, 4
  s_add_u32 s5, s5, s65
  s_lshl_b32 s5, s5, 2
  s_add_u32 s5, s5, s3
  s_mul_i32 s5, s5, 384
  s_add_u32 s85, s5, 1441792
  s_mov_b32 s87, 0xbfb8aa3b
  v_mul_u32_u24 v229, 384, v1
  s_mov_b32 s63, s84
  v_mov_b32 v232, v10
  v_min_u32 v15, 7, v1
  v_and_b32 v14, 3, v15
  v_lshrrev_b32 v15, 2, v15
  v_lshl_add_u32 v14, v14, 2, v15
  v_mul_u32_u24 v14, 384, v14
  s_lshr_b32 s5, s66, 1
  s_lshl_b32 s5, s5, 2
  s_add_u32 s5, s5, s3
  s_lshl_b32 s5, s5, 3
  s_and_b32 s6, s66, 1
  s_add_u32 s5, s5, s6
  s_mul_i32 s5, s5, 768
  s_add_u32 s84, s5, 1441792
  s_add_u32 s5, s3, 1
  s_and_b32 s5, s5, 3
  s_lshl_b32 s6, s66, 2
  s_add_u32 s5, s5, s6
  s_mul_i32 s5, s5, 49152
  s_mul_i32 s6, s3, 12288
  s_add_u32 s5, s5, s6
  s_add_u32 s68, s5, 29360128
  s_add_u32 s72, s68, 6144
  s_add_u32 s5, s3, 2
  s_and_b32 s5, s5, 3
  s_lshl_b32 s6, s66, 2
  s_add_u32 s5, s5, s6
  s_mul_i32 s5, s5, 49152
  s_mul_i32 s6, s3, 12288
  s_add_u32 s5, s5, s6
  s_add_u32 s69, s5, 29360128
  s_add_u32 s73, s69, 6144
  s_add_u32 s5, s3, 3
  s_and_b32 s5, s5, 3
  s_lshl_b32 s6, s66, 2
  s_add_u32 s5, s5, s6
  s_mul_i32 s5, s5, 49152
  s_mul_i32 s6, s3, 12288
  s_add_u32 s5, s5, s6
  s_add_u32 s70, s5, 29360128
  s_add_u32 s74, s70, 6144
  s_add_u32 s5, s3, 4
  s_and_b32 s5, s5, 3
  s_lshl_b32 s6, s66, 2
  s_add_u32 s5, s5, s6
  s_mul_i32 s5, s5, 49152
  s_mul_i32 s6, s3, 12288
  s_add_u32 s5, s5, s6
  s_add_u32 s71, s5, 29360128
  s_add_u32 s75, s71, 6144
  s_add_u32 s5, s3, 1
  s_and_b32 s5, s5, 3
  s_mul_i32 s5, s5, 15360
  s_add_u32 s5, s5, 81920
  v_add_u32 v8, s5, v2
  s_add_u32 s5, s3, 2
  s_and_b32 s5, s5, 3
  s_mul_i32 s5, s5, 15360
  s_add_u32 s5, s5, 87040
  v_add_u32 v9, s5, v2
  s_add_u32 s5, s3, 3
  s_and_b32 s5, s5, 3
  s_mul_i32 s5, s5, 15360
  s_add_u32 s5, s5, 92160
  v_add_u32 v10, s5, v2
  s_mul_i32 s5, s3, 15360
  s_add_u32 s5, s5, 81920
  v_add_u32 v11, s5, v2
  v_mul_u32_u24 v12, 160, v6
  v_add_u32 v12, s5, v12
  v_lshl_add_u32 v13, v5, 3, v12
  v_lshl_add_u32 v12, v5, 4, v12
  s_waitcnt vmcnt(6)
  v_cmp_ne_u32 vcc, s4, v233
  s_cbranch_vccz FOK_56
  s_mov_b64 exec, vcc
  s_movk_i32 s5, 0
POLL_57:
  buffer_load_dword v233, v232, s[32:35], s63 offen sc1
  s_addk_i32 s5, 1
  s_waitcnt vmcnt(0)
  v_cmp_ne_u32 vcc, s4, v233
  s_cmpk_ge_u32 s5, 20000
  s_cbranch_scc1 POLLX_58
  s_cbranch_vccz POLLX_58
  s_mov_b64 exec, vcc
  s_sleep 2
  s_branch POLL_57
POLLX_58:
  s_mov_b64 exec, -1
FOK_56:
  buffer_load_dwordx4 a[96:99], v2, s[32:35], s78 offen offset:0 sc1
  buffer_load_dwordx4 a[100:103], v2, s[32:35], s79 offen offset:0 sc1
  buffer_load_dwordx4 a[104:107], v2, s[32:35], s78 offen offset:1024 sc1
  buffer_load_dwordx4 a[108:111], v2, s[32:35], s79 offen offset:1024 sc1
  buffer_load_dwordx4 a[112:115], v2, s[32:35], s78 offen offset:2048 sc1
  buffer_load_dwordx4 a[116:119], v2, s[32:35], s79 offen offset:2048 sc1
  buffer_load_dwordx4 a[120:123], v2, s[32:35], s78 offen offset:3072 sc1
  s_add_u32 s78, s78, 4096
  buffer_load_dwordx4 a[124:127], v2, s[32:35], s79 offen offset:3072 sc1
  s_add_u32 s79, s79, 4096
  buffer_load_dwordx4 a[128:131], v2, s[32:35], s78 offen offset:0 sc1
  buffer_load_dwordx4 a[132:135], v2, s[32:35], s79 offen offset:0 sc1
  s_barrier
  ds_read_b128 v[80:83], v2 offset:0
  ds_read_b128 v[84:87], v2 offset:1024
  ds_read_b128 v[88:91], v2 offset:2048
  ds_read_b128 v[92:95], v2 offset:3072
  ds_read_b128 v[96:99], v2 offset:4096
  ds_read_b128 v[100:103], v2 offset:5120
  ds_read_b128 v[104:107], v2 offset:6144
  ds_read_b128 v[108:111], v2 offset:7168
  s_waitcnt vmcnt(8) lgkmcnt(4)
  v_mfma_f32_16x16x32_bf16 v[16:19], v[80:83], a[96:99], 0
  ds_read_b128 v[112:115], v2 offset:8192
  ds_read_b128 v[116:119], v2 offset:9216
  v_mfma_f32_16x16x32_bf16 v[32:35], v[80:83], a[100:103], 0
  v_mfma_f32_16x16x32_bf16 v[20:23], v[84:87], a[96:99], 0
  ds_read_b128 v[120:123], v2 offset:10240
  v_mfma_f32_16x16x32_bf16 v[36:39], v[84:87], a[100:103], 0
  buffer_load_dwordx4 a[136:139], v2, s[32:35], s78 offen offset:1024 sc1
  v_mfma_f32_16x16x32_bf16 v[24:27], v[88:91], a[96:99], 0
  ds_read_b128 v[124:127], v2 offset:11264
  v_mfma_f32_16x16x32_bf16 v[40:43], v[88:91], a[100:103], 0
  v_mfma_f32_16x16x32_bf16 v[28:31], v[92:95], a[96:99], 0
  buffer_load_dwordx4 a[140:143], v2, s[32:35], s79 offen offset:1024 sc1
  v_mfma_f32_16x16x32_bf16 v[44:47], v[92:95], a[100:103], 0
  s_waitcnt vmcnt(8) lgkmcnt(4)
  v_mfma_f32_16x16x32_bf16 v[16:19], v[96:99], a[104:107], v[16:19]
  ds_read_b128 v[80:83], v2 offset:12288
  ds_read_b128 v[84:87], v2 offset:13312
  v_mfma_f32_16x16x32_bf16 v[32:35], v[96:99], a[108:111], v[32:35]
  v_mfma_f32_16x16x32_bf16 v[20:23], v[100:103], a[104:107], v[20:23]
  ds_read_b128 v[88:91], v2 offset:14336
  v_mfma_f32_16x16x32_bf16 v[36:39], v[100:103], a[108:111], v[36:39]
  buffer_load_dwordx4 a[144:147], v2, s[32:35], s78 offen offset:2048 sc1
  v_mfma_f32_16x16x32_bf16 v[24:27], v[104:107], a[104:107], v[24:27]
  ds_read_b128 v[92:95], v2 offset:15360
  v_mfma_f32_16x16x32_bf16 v[40:43], v[104:107], a[108:111], v[40:43]
  v_mfma_f32_16x16x32_bf16 v[28:31], v[108:111], a[104:107], v[28:31]
  buffer_load_dwordx4 a[148:151], v2, s[32:35], s79 offen offset:2048 sc1
  v_mfma_f32_16x16x32_bf16 v[44:47], v[108:111], a[108:111], v[44:47]
  s_waitcnt vmcnt(8) lgkmcnt(4)
  v_mfma_f32_16x16x32_bf16 v[16:19], v[112:115], a[112:115], v[16:19]
  ds_read_b128 v[96:99], v2 offset:16384
  ds_read_b128 v[100:103], v2 offset:17408
  v_mfma_f32_16x16x32_bf16 v[32:35], v[112:115], a[116:119], v[32:35]
  v_mfma_f32_16x16x32_bf16 v[20:23], v[116:119], a[112:115], v[20:23]
  ds_read_b128 v[104:107], v2 offset:18432
  v_mfma_f32_16x16x32_bf16 v[36:39], v[116:119], a[116:119], v[36:39]
  buffer_load_dwordx4 a[152:155], v2, s[32:35], s78 offen offset:3072 sc1
  s_add_u32 s78, s78, 4096
  v_mfma_f32_16x16x32_bf16 v[24:27], v[120:123], a[112:115], v[24:27]
  ds_read_b128 v[108:111], v2 offset:19456
  v_mfma_f32_16x16x32_bf16 v[40:43], v[120:123], a[116:119], v[40:43]
  v_mfma_f32_16x16x32_bf16 v[28:31], v[124:127], a[112:115], v[28:31]
  buffer_load_dwordx4 a[156:159], v2, s[32:35], s79 offen offset:3072 sc1
  s_add_u32 s79, s79, 4096
  v_mfma_f32_16x16x32_bf16 v[44:47], v[124:127], a[116:119], v[44:47]
  s_waitcnt vmcnt(8) lgkmcnt(4)
  v_mfma_f32_16x16x32_bf16 v[16:19], v[80:83], a[120:123], v[16:19]
  ds_read_b128 v[112:115], v2 offset:20480
  ds_read_b128 v[116:119], v2 offset:21504
  v_mfma_f32_16x16x32_bf16 v[32:35], v[80:83], a[124:127], v[32:35]
  v_mfma_f32_16x16x32_bf16 v[20:23], v[84:87], a[120:123], v[20:23]
  ds_read_b128 v[120:123], v2 offset:22528
  v_mfma_f32_16x16x32_bf16 v[36:39], v[84:87], a[124:127], v[36:39]
  buffer_load_dwordx4 a[160:163], v2, s[32:35], s78 offen offset:0 sc1
  v_mfma_f32_16x16x32_bf16 v[24:27], v[88:91], a[120:123], v[24:27]
  ds_read_b128 v[124:127], v2 offset:23552
  v_mfma_f32_16x16x32_bf16 v[40:43], v[88:91], a[124:127], v[40:43]
  v_mfma_f32_16x16x32_bf16 v[28:31], v[92:95], a[120:123], v[28:31]
  buffer_load_dwordx4 a[164:167], v2, s[32:35], s79 offen offset:0 sc1
  v_mfma_f32_16x16x32_bf16 v[44:47], v[92:95], a[124:127], v[44:47]
  s_waitcnt vmcnt(8) lgkmcnt(4)
  v_mfma_f32_16x16x32_bf16 v[16:19], v[96:99], a[128:131], v[16:19]
  ds_read_b128 v[80:83], v2 offset:24576
  ds_read_b128 v[84:87], v2 offset:25600
  v_mfma_f32_16x16x32_bf16 v[32:35], v[96:99], a[132:135], v[32:35]
  v_mfma_f32_16x16x32_bf16 v[20:23], v[100:103], a[128:131], v[20:23]
  ds_read_b128 v[88:91], v2 offset:26624
  v_mfma_f32_16x16x32_bf16 v[36:39], v[100:103], a[132:135], v[36:39]
  buffer_load_dwordx4 a[168:171], v2, s[32:35], s78 offen offset:1024 sc1
  v_mfma_f32_16x16x32_bf16 v[24:27], v[104:107], a[128:131], v[24:27]
  ds_read_b128 v[92:95], v2 offset:27648
  v_mfma_f32_16x16x32_bf16 v[40:43], v[104:107], a[132:135], v[40:43]
  v_mfma_f32_16x16x32_bf16 v[28:31], v[108:111], a[128:131], v[28:31]
  buffer_load_dwordx4 a[172:175], v2, s[32:35], s79 offen offset:1024 sc1
  v_mfma_f32_16x16x32_bf16 v[44:47], v[108:111], a[132:135], v[44:47]
  s_waitcnt vmcnt(8) lgkmcnt(4)
  v_mfma_f32_16x16x32_bf16 v[16:19], v[112:115], a[136:139], v[16:19]
  ds_read_b128 v[96:99], v2 offset:28672
  ds_read_b128 v[100:103], v2 offset:29696
  v_mfma_f32_16x16x32_bf16 v[32:35], v[112:115], a[140:143], v[32:35]
  v_mfma_f32_16x16x32_bf16 v[20:23], v[116:119], a[136:139], v[20:23]
  ds_read_b128 v[104:107], v2 offset:30720
  v_mfma_f32_16x16x32_bf16 v[36:39], v[116:119], a[140:143], v[36:39]
  buffer_load_dwordx4 a[176:179], v2, s[32:35], s78 offen offset:2048 sc1
  v_mfma_f32_16x16x32_bf16 v[24:27], v[120:123], a[136:139], v[24:27]
  ds_read_b128 v[108:111], v2 offset:31744
  v_mfma_f32_16x16x32_bf16 v[40:43], v[120:123], a[140:143], v[40:43]
  v_mfma_f32_16x16x32_bf16 v[28:31], v[124:127], a[136:139], v[28:31]
  buffer_load_dwordx4 a[180:183], v2, s[32:35], s79 offen offset:2048 sc1
  v_mfma_f32_16x16x32_bf16 v[44:47], v[124:127], a[140:143], v[44:47]
  s_waitcnt vmcnt(8) lgkmcnt(4)
  v_mfma_f32_16x16x32_bf16 v[16:19], v[80:83], a[144:147], v[16:19]
  ds_read_b128 v[112:115], v2 offset:32768
  ds_read_b128 v[116:119], v2 offset:33792
  v_mfma_f32_16x16x32_bf16 v[32:35], v[80:83], a[148:151], v[32:35]
  v_mfma_f32_16x16x32_bf16 v[20:23], v[84:87], a[144:147], v[20:23]
  ds_read_b128 v[120:123], v2 offset:34816
  v_mfma_f32_16x16x32_bf16 v[36:39], v[84:87], a[148:151], v[36:39]
  buffer_load_dwordx4 a[184:187], v2, s[32:35], s78 offen offset:3072 sc1
  s_add_u32 s78, s78, 4096
  v_mfma_f32_16x16x32_bf16 v[24:27], v[88:91], a[144:147], v[24:27]
  ds_read_b128 v[124:127], v2 offset:35840
  v_mfma_f32_16x16x32_bf16 v[40:43], v[88:91], a[148:151], v[40:43]
  v_mfma_f32_16x16x32_bf16 v[28:31], v[92:95], a[144:147], v[28:31]
  buffer_load_dwordx4 a[188:191], v2, s[32:35], s79 offen offset:3072 sc1
  s_add_u32 s79, s79, 4096
  v_mfma_f32_16x16x32_bf16 v[44:47], v[92:95], a[148:151], v[44:47]
  s_waitcnt vmcnt(8) lgkmcnt(4)
  v_mfma_f32_16x16x32_bf16 v[16:19], v[96:99], a[152:155], v[16:19]
  ds_read_b128 v[80:83], v2 offset:36864
  ds_read_b128 v[84:87], v2 offset:37888
  v_mfma_f32_16x16x32_bf16 v[32:35], v[96:99], a[156:159], v[32:35]
  v_mfma_f32_16x16x32_bf16 v[20:23], v[100:103], a[152:155], v[20:23]
  ds_read_b128 v[88:91], v2 offset:38912
  v_mfma_f32_16x16x32_bf16 v[36:39], v[100:103], a[156:159], v[36:39]
  buffer_load_dwordx4 a[192:195], v2, s[32:35], s78 offen offset:0 sc1
  v_mfma_f32_16x16x32_bf16 v[24:27], v[104:107], a[152:155], v[24:27]
  ds_read_b128 v[92:95], v2 offset:39936
  v_mfma_f32_16x16x32_bf16 v[40:43], v[104:107], a[156:159], v[40:43]
  v_mfma_f32_16x16x32_bf16 v[28:31], v[108:111], a[152:155], v[28:31]
  buffer_load_dwordx4 a[196:199], v2, s[32:35], s79 offen offset:0 sc1
  v_mfma_f32_16x16x32_bf16 v[44:47], v[108:111], a[156:159], v[44:47]
  s_waitcnt vmcnt(8) lgkmcnt(4)
  v_mfma_f32_16x16x32_bf16 v[16:19], v[112:115], a[160:163], v[16:19]
  ds_read_b128 v[96:99], v2 offset:40960
  ds_read_b128 v[100:103], v2 offset:41984
  v_mfma_f32_16x16x32_bf16 v[32:35], v[112:115], a[164:167], v[32:35]
  v_mfma_f32_16x16x32_bf16 v[20:23], v[116:119], a[160:163], v[20:23]
  ds_read_b128 v[104:107], v2 offset:43008
  v_mfma_f32_16x16x32_bf16 v[36:39], v[116:119], a[164:167], v[36:39]
  buffer_load_dwordx4 a[200:203], v2, s[32:35], s78 offen offset:1024 sc1
  v_mfma_f32_16x16x32_bf16 v[24:27], v[120:123], a[160:163], v[24:27]
  ds_read_b128 v[108:111], v2 offset:44032
  v_mfma_f32_16x16x32_bf16 v[40:43], v[120:123], a[164:167], v[40:43]
  v_mfma_f32_16x16x32_bf16 v[28:31], v[124:127], a[160:163], v[28:31]
  buffer_load_dwordx4 a[204:207], v2, s[32:35], s79 offen offset:1024 sc1
  v_mfma_f32_16x16x32_bf16 v[44:47], v[124:127], a[164:167], v[44:47]
  s_waitcnt vmcnt(8) lgkmcnt(4)
  v_mfma_f32_16x16x32_bf16 v[16:19], v[80:83], a[168:171], v[16:19]
  ds_read_b128 v[112:115], v2 offset:45056
  ds_read_b128 v[116:119], v2 offset:46080
  v_mfma_f32_16x16x32_bf16 v[32:35], v[80:83], a[172:175], v[32:35]
  v_mfma_f32_16x16x32_bf16 v[20:23], v[84:87], a[168:171], v[20:23]
  ds_read_b128 v[120:123], v2 offset:47104
  v_mfma_f32_16x16x32_bf16 v[36:39], v[84:87], a[172:175], v[36:39]
  buffer_load_dwordx4 a[208:211], v2, s[32:35], s78 offen offset:2048 sc1
  v_mfma_f32_16x16x32_bf16 v[24:27], v[88:91], a[168:171], v[24:27]
  ds_read_b128 v[124:127], v2 offset:48128
  v_mfma_f32_16x16x32_bf16 v[40:43], v[88:91], a[172:175], v[40:43]
  v_mfma_f32_16x16x32_bf16 v[28:31], v[92:95], a[168:171], v[28:31]
  buffer_load_dwordx4 a[212:215], v2, s[32:35], s79 offen offset:2048 sc1
  v_mfma_f32_16x16x32_bf16 v[44:47], v[92:95], a[172:175], v[44:47]
  s_waitcnt vmcnt(8) lgkmcnt(4)
  v_mfma_f32_16x16x32_bf16 v[16:19], v[96:99], a[176:179], v[16:19]
  ds_read_b128 v[80:83], v2 offset:49152
  ds_read_b128 v[84:87], v2 offset:50176
  v_mfma_f32_16x16x32_bf16 v[32:35], v[96:99], a[180:183], v[32:35]
  v_mfma_f32_16x16x32_bf16 v[20:23], v[100:103], a[176:179], v[20:23]
  ds_read_b128 v[88:91], v2 offset:51200
  v_mfma_f32_16x16x32_bf16 v[36:39], v[100:103], a[180:183], v[36:39]
  buffer_load_dwordx4 a[216:219], v2, s[32:35], s78 offen offset:3072 sc1
  s_add_u32 s78, s78, 4096
  v_mfma_f32_16x16x32_bf16 v[24:27], v[104:107], a[176:179], v[24:27]
  ds_read_b128 v[92:95], v2 offset:52224
  v_mfma_f32_16x16x32_bf16 v[40:43], v[104:107], a[180:183], v[40:43]
  v_mfma_f32_16x16x32_bf16 v[28:31], v[108:111], a[176:179], v[28:31]
  buffer_load_dwordx4 a[220:223], v2, s[32:35], s79 offen offset:3072 sc1
  s_add_u32 s79, s79, 4096
  v_mfma_f32_16x16x32_bf16 v[44:47], v[108:111], a[180:183], v[44:47]
  s_waitcnt vmcnt(8) lgkmcnt(4)
  v_mfma_f32_16x16x32_bf16 v[16:19], v[112:115], a[184:187], v[16:19]
  ds_read_b128 v[96:99], v2 offset:53248
  ds_read_b128 v[100:103], v2 offset:54272
  v_mfma_f32_16x16x32_bf16 v[32:35], v[112:115], a[188:191], v[32:35]
  v_mfma_f32_16x16x32_bf16 v[20:23], v[116:119], a[184:187], v[20:23]
  ds_read_b128 v[104:107], v2 offset:55296
  v_mfma_f32_16x16x32_bf16 v[36:39], v[116:119], a[188:191], v[36:39]
  buffer_load_dwordx4 a[224:227], v2, s[32:35], s78 offen offset:0 sc1
  v_mfma_f32_16x16x32_bf16 v[24:27], v[120:123], a[184:187], v[24:27]
  ds_read_b128 v[108:111], v2 offset:56320
  v_mfma_f32_16x16x32_bf16 v[40:43], v[120:123], a[188:191], v[40:43]
  v_mfma_f32_16x16x32_bf16 v[28:31], v[124:127], a[184:187], v[28:31]
  buffer_load_dwordx4 a[228:231], v2, s[32:35], s79 offen offset:0 sc1
  v_mfma_f32_16x16x32_bf16 v[44:47], v[124:127], a[188:191], v[44:47]
  s_waitcnt vmcnt(8) lgkmcnt(4)
  v_mfma_f32_16x16x32_bf16 v[16:19], v[80:83], a[192:195], v[16:19]
  ds_read_b128 v[112:115], v2 offset:57344
  ds_read_b128 v[116:119], v2 offset:58368
  v_mfma_f32_16x16x32_bf16 v[32:35], v[80:83], a[196:199], v[32:35]
  v_mfma_f32_16x16x32_bf16 v[20:23], v[84:87], a[192:195], v[20:23]
  ds_read_b128 v[120:123], v2 offset:59392
  v_mfma_f32_16x16x32_bf16 v[36:39], v[84:87], a[196:199], v[36:39]
  buffer_load_dwordx4 a[232:235], v2, s[32:35], s78 offen offset:1024 sc1
  v_mfma_f32_16x16x32_bf16 v[24:27], v[88:91], a[192:195], v[24:27]
  ds_read_b128 v[124:127], v2 offset:60416
  v_mfma_f32_16x16x32_bf16 v[40:43], v[88:91], a[196:199], v[40:43]
  v_mfma_f32_16x16x32_bf16 v[28:31], v[92:95], a[192:195], v[28:31]
  buffer_load_dwordx4 a[236:239], v2, s[32:35], s79 offen offset:1024 sc1
  v_mfma_f32_16x16x32_bf16 v[44:47], v[92:95], a[196:199], v[44:47]
  s_waitcnt vmcnt(8) lgkmcnt(4)
  v_mfma_f32_16x16x32_bf16 v[16:19], v[96:99], a[200:203], v[16:19]
  ds_read_b128 v[80:83], v2 offset:61440
  ds_read_b128 v[84:87], v2 offset:62464
  v_mfma_f32_16x16x32_bf16 v[32:35], v[96:99], a[204:207], v[32:35]
  v_mfma_f32_16x16x32_bf16 v[20:23], v[100:103], a[200:203], v[20:23]
  ds_read_b128 v[88:91], v2 offset:63488
  v_mfma_f32_16x16x32_bf16 v[36:39], v[100:103], a[204:207], v[36:39]
  buffer_load_dwordx4 a[240:243], v2, s[32:35], s78 offen offset:2048 sc1
  v_mfma_f32_16x16x32_bf16 v[24:27], v[104:107], a[200:203], v[24:27]
  ds_read_b128 v[92:95], v2 offset:64512
  v_mfma_f32_16x16x32_bf16 v[40:43], v[104:107], a[204:207], v[40:43]
  v_mfma_f32_16x16x32_bf16 v[28:31], v[108:111], a[200:203], v[28:31]
  buffer_load_dwordx4 a[244:247], v2, s[32:35], s79 offen offset:2048 sc1
  v_mfma_f32_16x16x32_bf16 v[44:47], v[108:111], a[204:207], v[44:47]
  s_waitcnt vmcnt(8) lgkmcnt(4)
  v_mfma_f32_16x16x32_bf16 v[16:19], v[112:115], a[208:211], v[16:19]
  ds_read_b128 v[96:99], v3 offset:0
  ds_read_b128 v[100:103], v3 offset:1024
  v_mfma_f32_16x16x32_bf16 v[32:35], v[112:115], a[212:215], v[32:35]
  v_mfma_f32_16x16x32_bf16 v[20:23], v[116:119], a[208:211], v[20:23]
  ds_read_b128 v[104:107], v3 offset:2048
  v_mfma_f32_16x16x32_bf16 v[36:39], v[116:119], a[212:215], v[36:39]
  buffer_load_dwordx4 a[248:251], v2, s[32:35], s78 offen offset:3072 sc1
  s_add_u32 s78, s78, 4096
  v_mfma_f32_16x16x32_bf16 v[24:27], v[120:123], a[208:211], v[24:27]
  ds_read_b128 v[108:111], v3 offset:3072
  v_mfma_f32_16x16x32_bf16 v[40:43], v[120:123], a[212:215], v[40:43]
  v_mfma_f32_16x16x32_bf16 v[28:31], v[124:127], a[208:211], v[28:31]
  buffer_load_dwordx4 a[252:255], v2, s[32:35], s79 offen offset:3072 sc1
  s_add_u32 s79, s79, 4096
  v_mfma_f32_16x16x32_bf16 v[44:47], v[124:127], a[212:215], v[44:47]
  s_waitcnt vmcnt(8) lgkmcnt(4)
  v_mfma_f32_16x16x32_bf16 v[16:19], v[80:83], a[216:219], v[16:19]
  ds_read_b128 v[112:115], v3 offset:4096
  ds_read_b128 v[116:119], v3 offset:5120
  v_mfma_f32_16x16x32_bf16 v[32:35], v[80:83], a[220:223], v[32:35]
  v_mfma_f32_16x16x32_bf16 v[20:23], v[84:87], a[216:219], v[20:23]
  ds_read_b128 v[120:123], v3 offset:6144
  v_mfma_f32_16x16x32_bf16 v[36:39], v[84:87], a[220:223], v[36:39]
  buffer_load_dwordx4 v2, s[32:35], s83 offen offset:2048 sc1 lds
  v_mfma_f32_16x16x32_bf16 v[24:27], v[88:91], a[216:219], v[24:27]
  ds_read_b128 v[124:127], v3 offset:7168
  v_mfma_f32_16x16x32_bf16 v[40:43], v[88:91], a[220:223], v[40:43]
  v_mfma_f32_16x16x32_bf16 v[28:31], v[92:95], a[216:219], v[28:31]
  buffer_load_dwordx4 v2, s[32:35], s83 offen offset:3072 sc1 lds
  v_mfma_f32_16x16x32_bf16 v[44:47], v[92:95], a[220:223], v[44:47]
  s_waitcnt vmcnt(8) lgkmcnt(4)
  v_mfma_f32_16x16x32_bf16 v[16:19], v[96:99], a[224:227], v[16:19]
  ds_read_b128 v[80:83], v3 offset:8192
  ds_read_b128 v[84:87], v3 offset:9216
  v_mfma_f32_16x16x32_bf16 v[32:35], v[96:99], a[228:231], v[32:35]
  v_mfma_f32_16x16x32_bf16 v[20:23], v[100:103], a[224:227], v[20:23]
  ds_read_b128 v[88:91], v3 offset:10240
  v_mfma_f32_16x16x32_bf16 v[36:39], v[100:103], a[228:231], v[36:39]
  s_add_u32 m0, m0, 16384
  s_add_u32 s83, s83, 16384
  buffer_load_dwordx4 v2, s[32:35], s83 offen offset:0 sc1 lds
  v_mfma_f32_16x16x32_bf16 v[24:27], v[104:107], a[224:227], v[24:27]
  ds_read_b128 v[92:95], v3 offset:11264
  v_mfma_f32_16x16x32_bf16 v[40:43], v[104:107], a[228:231], v[40:43]
  v_mfma_f32_16x16x32_bf16 v[28:31], v[108:111], a[224:227], v[28:31]
  buffer_load_dwordx4 v2, s[32:35], s83 offen offset:1024 sc1 lds
  v_mfma_f32_16x16x32_bf16 v[44:47], v[108:111], a[228:231], v[44:47]
  s_waitcnt vmcnt(8) lgkmcnt(4)
  v_mfma_f32_16x16x32_bf16 v[16:19], v[112:115], a[232:235], v[16:19]
  ds_read_b128 v[96:99], v3 offset:12288
  ds_read_b128 v[100:103], v3 offset:13312
  v_mfma_f32_16x16x32_bf16 v[32:35], v[112:115], a[236:239], v[32:35]
  v_mfma_f32_16x16x32_bf16 v[20:23], v[116:119], a[232:235], v[20:23]
  ds_read_b128 v[104:107], v3 offset:14336
  v_mfma_f32_16x16x32_bf16 v[36:39], v[116:119], a[236:239], v[36:39]
  buffer_load_dwordx4 v2, s[32:35], s83 offen offset:2048 sc1 lds
  v_mfma_f32_16x16x32_bf16 v[24:27], v[120:123], a[232:235], v[24:27]
  ds_read_b128 v[108:111], v3 offset:15360
  v_mfma_f32_16x16x32_bf16 v[40:43], v[120:123], a[236:239], v[40:43]
  v_mfma_f32_16x16x32_bf16 v[28:31], v[124:127], a[232:235], v[28:31]
  buffer_load_dwordx4 v2, s[32:35], s83 offen offset:3072 sc1 lds
  v_mfma_f32_16x16x32_bf16 v[44:47], v[124:127], a[236:239], v[44:47]
  s_waitcnt vmcnt(8) lgkmcnt(4)
  s_waitcnt vmcnt(0)
  s_barrier
  v_mfma_f32_16x16x32_bf16 v[16:19], v[80:83], a[240:243], v[16:19]
  ds_read_b128 v[112:115], v3 offset:16384
  ds_read_b128 v[116:119], v3 offset:17408
  v_mfma_f32_16x16x32_bf16 v[32:35], v[80:83], a[244:247], v[32:35]
  v_mfma_f32_16x16x32_bf16 v[20:23], v[84:87], a[240:243], v[20:23]
  ds_read_b128 v[120:123], v3 offset:18432
  v_mfma_f32_16x16x32_bf16 v[36:39], v[84:87], a[244:247], v[36:39]
  s_add_u32 s88, s88, 4096
  buffer_load_dwordx4 a[76:79], v2, s[32:35], s88 offen offset:0 sc1
  v_mfma_f32_16x16x32_bf16 v[24:27], v[88:91], a[240:243], v[24:27]
  ds_read_b128 v[124:127], v3 offset:19456
  v_mfma_f32_16x16x32_bf16 v[40:43], v[88:91], a[244:247], v[40:43]
  v_mfma_f32_16x16x32_bf16 v[28:31], v[92:95], a[240:243], v[28:31]
  s_sub_u32 s88, s88, 45056
  buffer_load_dwordx4 a[80:83], v2, s[32:35], s88 offen offset:0 sc1
  v_mfma_f32_16x16x32_bf16 v[44:47], v[92:95], a[244:247], v[44:47]
  s_waitcnt lgkmcnt(4)
  v_mfma_f32_16x16x32_bf16 v[16:19], v[96:99], a[248:251], v[16:19]
  ds_read_b128 v[80:83], v3 offset:20480
  ds_read_b128 v[84:87], v3 offset:21504
  v_mfma_f32_16x16x32_bf16 v[32:35], v[96:99], a[252:255], v[32:35]
  v_mfma_f32_16x16x32_bf16 v[20:23], v[100:103], a[248:251], v[20:23]
  ds_read_b128 v[88:91], v3 offset:22528
  v_mfma_f32_16x16x32_bf16 v[36:39], v[100:103], a[252:255], v[36:39]
  buffer_load_dwordx4 a[84:87], v2, s[32:35], s88 offen offset:1024 sc1
  v_mfma_f32_16x16x32_bf16 v[24:27], v[104:107], a[248:251], v[24:27]
  ds_read_b128 v[92:95], v3 offset:23552
  v_mfma_f32_16x16x32_bf16 v[40:43], v[104:107], a[252:255], v[40:43]
  v_mfma_f32_16x16x32_bf16 v[28:31], v[108:111], a[248:251], v[28:31]
  buffer_load_dwordx4 a[88:91], v2, s[32:35], s88 offen offset:2048 sc1
  v_mfma_f32_16x16x32_bf16 v[44:47], v[108:111], a[252:255], v[44:47]
  s_waitcnt lgkmcnt(4)
  s_barrier
  s_getpc_b64 s[44:45]
L_pf3:
  s_mov_b32 s46, 10108
  s_mov_b32 s47, 0x20000
  s_lshr_b32 s5, s2, 3
  s_lshl_b32 s5, s5, 10
  v_min_u32 v234, 7, v1
  v_lshlrev_b32 v234, 7, v234
  s_cmp_lg_u32 s3, 1
  s_cbranch_scc1 PF_59
  buffer_load_dword v234, v234, s[44:47], s5 offen
PF_59:
  v_mfma_f32_16x16x32_bf16 v[48:51], v[112:115], a[96:99], 0
  ds_read_b128 v[96:99], v3 offset:24576
  ds_read_b128 v[100:103], v3 offset:25600
  v_mfma_f32_16x16x32_bf16 v[64:67], v[112:115], a[100:103], 0
  v_mfma_f32_16x16x32_bf16 v[52:55], v[116:119], a[96:99], 0
  ds_read_b128 v[104:107], v3 offset:26624
  v_mfma_f32_16x16x32_bf16 v[68:71], v[116:119], a[100:103], 0
  s_add_u32 m0, s93, 0
  s_mul_i32 s83, s65, 245760
  s_add_u32 s83, s83, s93
  s_add_u32 s83, s83, 20086784
  buffer_load_dwordx4 v2, s[32:35], s83 offen offset:0 sc1 lds
  v_mfma_f32_16x16x32_bf16 v[56:59], v[120:123], a[96:99], 0
  ds_read_b128 v[108:111], v3 offset:27648
  v_mfma_f32_16x16x32_bf16 v[72:75], v[120:123], a[100:103], 0
  v_mfma_f32_16x16x32_bf16 v[60:63], v[124:127], a[96:99], 0
  buffer_load_dwordx4 v2, s[32:35], s83 offen offset:1024 sc1 lds
  v_mfma_f32_16x16x32_bf16 v[76:79], v[124:127], a[100:103], 0
  v_mul_f32 v128, s87, v16
  s_waitcnt lgkmcnt(4)
  v_mfma_f32_16x16x32_bf16 v[48:51], v[80:83], a[104:107], v[48:51]
  ds_read_b128 v[112:115], v3 offset:28672
  v_mul_f32 v16, v16, v24
  v_mfma_f32_16x16x32_bf16 v[64:67], v[80:83], a[108:111], v[64:67]
  v_exp_f32 v128, v128
  v_mfma_f32_16x16x32_bf16 v[52:55], v[84:87], a[104:107], v[52:55]
  ds_read_b128 v[116:119], v3 offset:29696
  v_add_f32 v128, 1.0, v128
  v_mfma_f32_16x16x32_bf16 v[68:71], v[84:87], a[108:111], v[68:71]
  buffer_load_dwordx4 v2, s[32:35], s83 offen offset:2048 sc1 lds
  v_mfma_f32_16x16x32_bf16 v[56:59], v[88:91], a[104:107], v[56:59]
  ds_read_b128 v[120:123], v3 offset:30720
  v_mul_f32 v129, s87, v17
  v_mfma_f32_16x16x32_bf16 v[72:75], v[88:91], a[108:111], v[72:75]
  v_rcp_f32 v128, v128
  v_mfma_f32_16x16x32_bf16 v[60:63], v[92:95], a[104:107], v[60:63]
  ds_read_b128 v[124:127], v3 offset:31744
  v_mul_f32 v16, v16, v128
  v_mfma_f32_16x16x32_bf16 v[76:79], v[92:95], a[108:111], v[76:79]
  v_mul_f32 v17, v17, v25
  s_waitcnt lgkmcnt(4)
  v_mfma_f32_16x16x32_bf16 v[48:51], v[96:99], a[112:115], v[48:51]
  ds_read_b128 v[80:83], v3 offset:32768
  ds_read_b128 v[84:87], v3 offset:33792
  v_mfma_f32_16x16x32_bf16 v[64:67], v[96:99], a[116:119], v[64:67]
  v_exp_f32 v129, v129
  v_mfma_f32_16x16x32_bf16 v[52:55], v[100:103], a[112:115], v[52:55]
  ds_read_b128 v[88:91], v3 offset:34816
  v_add_f32 v129, 1.0, v129
  v_mfma_f32_16x16x32_bf16 v[68:71], v[100:103], a[116:119], v[68:71]
  buffer_load_dwordx4 v2, s[32:35], s83 offen offset:3072 sc1 lds
  v_mfma_f32_16x16x32_bf16 v[56:59], v[104:107], a[112:115], v[56:59]
  ds_read_b128 v[92:95], v3 offset:35840
  v_mul_f32 v130, s87, v18
  v_mfma_f32_16x16x32_bf16 v[72:75], v[104:107], a[116:119], v[72:75]
  v_rcp_f32 v129, v129
  v_mfma_f32_16x16x32_bf16 v[60:63], v[108:111], a[112:115], v[60:63]
  s_add_u32 m0, m0, 16384
  s_add_u32 s83, s83, 16384
  buffer_load_dwordx4 v2, s[32:35], s83 offen offset:0 sc1 lds
  v_mfma_f32_16x16x32_bf16 v[76:79], v[108:111], a[116:119], v[76:79]
  v_mul_f32 v17, v17, v129
  s_waitcnt lgkmcnt(4)
  v_mfma_f32_16x16x32_bf16 v[48:51], v[112:115], a[120:123], v[48:51]
  ds_read_b128 v[96:99], v3 offset:36864
  v_cvt_pk_bf16_f32 v136, v16, v17
  v_mfma_f32_16x16x32_bf16 v[64:67], v[112:115], a[124:127], v[64:67]
  v_exp_f32 v130, v130
  v_mfma_f32_16x16x32_bf16 v[52:55], v[116:119], a[120:123], v[52:55]
  ds_read_b128 v[100:103], v3 offset:37888
  v_mul_f32 v18, v18, v26
  v_mfma_f32_16x16x32_bf16 v[68:71], v[116:119], a[124:127], v[68:71]
  buffer_load_dwordx4 v2, s[32:35], s83 offen offset:1024 sc1 lds
  v_mfma_f32_16x16x32_bf16 v[56:59], v[120:123], a[120:123], v[56:59]
  ds_read_b128 v[104:107], v3 offset:38912
  v_add_f32 v130, 1.0, v130
  v_mfma_f32_16x16x32_bf16 v[72:75], v[120:123], a[124:127], v[72:75]
  v_rcp_f32 v130, v130
  v_mfma_f32_16x16x32_bf16 v[60:63], v[124:127], a[120:123], v[60:63]
  ds_read_b128 v[108:111], v3 offset:39936
  v_mul_f32 v18, v18, v130
  v_mfma_f32_16x16x32_bf16 v[76:79], v[124:127], a[124:127], v[76:79]
  v_mul_f32 v131, s87, v19
  s_waitcnt lgkmcnt(4)
  v_mfma_f32_16x16x32_bf16 v[48:51], v[80:83], a[128:131], v[48:51]
  ds_read_b128 v[112:115], v3 offset:40960
  ds_read_b128 v[116:119], v3 offset:41984
  v_mfma_f32_16x16x32_bf16 v[64:67], v[80:83], a[132:135], v[64:67]
  v_exp_f32 v131, v131
  v_mfma_f32_16x16x32_bf16 v[52:55], v[84:87], a[128:131], v[52:55]
  ds_read_b128 v[120:123], v3 offset:43008
  v_mul_f32 v19, v19, v27
  v_mfma_f32_16x16x32_bf16 v[68:71], v[84:87], a[132:135], v[68:71]
  buffer_load_dwordx4 v2, s[32:35], s83 offen offset:2048 sc1 lds
  v_mfma_f32_16x16x32_bf16 v[56:59], v[88:91], a[128:131], v[56:59]
  ds_read_b128 v[124:127], v3 offset:44032
  v_add_f32 v131, 1.0, v131
  v_mfma_f32_16x16x32_bf16 v[72:75], v[88:91], a[132:135], v[72:75]
  v_rcp_f32 v131, v131
  v_mfma_f32_16x16x32_bf16 v[60:63], v[92:95], a[128:131], v[60:63]
  buffer_load_dwordx4 v2, s[32:35], s83 offen offset:3072 sc1 lds
  v_mfma_f32_16x16x32_bf16 v[76:79], v[92:95], a[132:135], v[76:79]
  v_mul_f32 v19, v19, v131
  s_waitcnt lgkmcnt(4)
  v_mfma_f32_16x16x32_bf16 v[48:51], v[96:99], a[136:139], v[48:51]
  ds_read_b128 v[80:83], v3 offset:45056
  v_cvt_pk_bf16_f32 v137, v18, v19
  v_mfma_f32_16x16x32_bf16 v[64:67], v[96:99], a[140:143], v[64:67]
  v_mul_f32 v128, s87, v20
  v_mul_f32 v129, s87, v21
  v_mfma_f32_16x16x32_bf16 v[52:55], v[100:103], a[136:139], v[52:55]
  ds_read_b128 v[84:87], v3 offset:46080
  v_mul_f32 v20, v20, v28
  v_mfma_f32_16x16x32_bf16 v[68:71], v[100:103], a[140:143], v[68:71]
  s_add_u32 m0, m0, 16384
  s_add_u32 s83, s83, 16384
  buffer_load_dwordx4 v2, s[32:35], s83 offen offset:0 sc1 lds
  v_mfma_f32_16x16x32_bf16 v[56:59], v[104:107], a[136:139], v[56:59]
  ds_read_b128 v[88:91], v3 offset:47104
  v_mul_f32 v21, v21, v29
  v_mfma_f32_16x16x32_bf16 v[72:75], v[104:107], a[140:143], v[72:75]
  v_exp_f32 v128, v128
  v_mfma_f32_16x16x32_bf16 v[60:63], v[108:111], a[136:139], v[60:63]
  ds_read_b128 v[92:95], v3 offset:48128
  v_add_f32 v128, 1.0, v128
  v_mfma_f32_16x16x32_bf16 v[76:79], v[108:111], a[140:143], v[76:79]
  v_mul_f32 v130, s87, v22
  s_waitcnt lgkmcnt(4)
  v_mfma_f32_16x16x32_bf16 v[48:51], v[112:115], a[144:147], v[48:51]
  ds_read_b128 v[96:99], v3 offset:49152
  ds_read_b128 v[100:103], v3 offset:50176
  v_mfma_f32_16x16x32_bf16 v[64:67], v[112:115], a[148:151], v[64:67]
  v_rcp_f32 v128, v128
  v_mfma_f32_16x16x32_bf16 v[52:55], v[116:119], a[144:147], v[52:55]
  ds_read_b128 v[104:107], v3 offset:51200
  v_mul_f32 v20, v20, v128
  v_mfma_f32_16x16x32_bf16 v[68:71], v[116:119], a[148:151], v[68:71]
  buffer_load_dwordx4 v2, s[32:35], s83 offen offset:1024 sc1 lds
  v_mfma_f32_16x16x32_bf16 v[56:59], v[120:123], a[144:147], v[56:59]
  ds_read_b128 v[108:111], v3 offset:52224
  v_mul_f32 v22, v22, v30
  v_mfma_f32_16x16x32_bf16 v[72:75], v[120:123], a[148:151], v[72:75]
  v_exp_f32 v129, v129
  v_mfma_f32_16x16x32_bf16 v[60:63], v[124:127], a[144:147], v[60:63]
  buffer_load_dwordx4 v2, s[32:35], s83 offen offset:2048 sc1 lds
  v_mfma_f32_16x16x32_bf16 v[76:79], v[124:127], a[148:151], v[76:79]
  v_add_f32 v129, 1.0, v129
  s_waitcnt lgkmcnt(4)
  v_mfma_f32_16x16x32_bf16 v[48:51], v[80:83], a[152:155], v[48:51]
  ds_read_b128 v[112:115], v3 offset:53248
  v_mul_f32 v131, s87, v23
  v_mfma_f32_16x16x32_bf16 v[64:67], v[80:83], a[156:159], v[64:67]
  v_rcp_f32 v129, v129
  v_mfma_f32_16x16x32_bf16 v[52:55], v[84:87], a[152:155], v[52:55]
  ds_read_b128 v[116:119], v3 offset:54272
  v_mul_f32 v21, v21, v129
  v_mfma_f32_16x16x32_bf16 v[68:71], v[84:87], a[156:159], v[68:71]
  buffer_load_dwordx4 v2, s[32:35], s83 offen offset:3072 sc1 lds
  v_mfma_f32_16x16x32_bf16 v[56:59], v[88:91], a[152:155], v[56:59]
  ds_read_b128 v[120:123], v3 offset:55296
  v_cvt_pk_bf16_f32 v138, v20, v21
  v_mfma_f32_16x16x32_bf16 v[72:75], v[88:91], a[156:159], v[72:75]
  v_exp_f32 v130, v130
  v_mfma_f32_16x16x32_bf16 v[60:63], v[92:95], a[152:155], v[60:63]
  ds_read_b128 v[124:127], v3 offset:56320
  v_add_f32 v130, 1.0, v130
  v_mfma_f32_16x16x32_bf16 v[76:79], v[92:95], a[156:159], v[76:79]
  v_mul_f32 v23, v23, v31
  s_waitcnt lgkmcnt(4)
  v_mfma_f32_16x16x32_bf16 v[48:51], v[96:99], a[160:163], v[48:51]
  ds_read_b128 v[80:83], v3 offset:57344
  ds_read_b128 v[84:87], v3 offset:58368
  v_mfma_f32_16x16x32_bf16 v[64:67], v[96:99], a[164:167], v[64:67]
  v_rcp_f32 v130, v130
  v_mfma_f32_16x16x32_bf16 v[52:55], v[100:103], a[160:163], v[52:55]
  ds_read_b128 v[88:91], v3 offset:59392
  v_mul_f32 v22, v22, v130
  v_mfma_f32_16x16x32_bf16 v[68:71], v[100:103], a[164:167], v[68:71]
  s_add_u32 m0, m0, 16384
  s_add_u32 s83, s83, 16384
  buffer_load_dwordx4 v2, s[32:35], s83 offen offset:0 sc1 lds
  v_mfma_f32_16x16x32_bf16 v[56:59], v[104:107], a[160:163], v[56:59]
  ds_read_b128 v[92:95], v3 offset:60416
  v_mul_f32 v128, s87, v32
  v_mfma_f32_16x16x32_bf16 v[72:75], v[104:107], a[164:167], v[72:75]
  v_exp_f32 v131, v131
  v_mfma_f32_16x16x32_bf16 v[60:63], v[108:111], a[160:163], v[60:63]
  buffer_load_dwordx4 v2, s[32:35], s83 offen offset:1024 sc1 lds
  v_mfma_f32_16x16x32_bf16 v[76:79], v[108:111], a[164:167], v[76:79]
  v_add_f32 v131, 1.0, v131
  s_waitcnt lgkmcnt(4)
  v_mfma_f32_16x16x32_bf16 v[48:51], v[112:115], a[168:171], v[48:51]
  ds_read_b128 v[96:99], v3 offset:61440
  v_mul_f32 v32, v32, v40
  v_mfma_f32_16x16x32_bf16 v[64:67], v[112:115], a[172:175], v[64:67]
  v_rcp_f32 v131, v131
  v_mfma_f32_16x16x32_bf16 v[52:55], v[116:119], a[168:171], v[52:55]
  ds_read_b128 v[100:103], v3 offset:62464
  v_mul_f32 v23, v23, v131
  v_mfma_f32_16x16x32_bf16 v[68:71], v[116:119], a[172:175], v[68:71]
  buffer_load_dwordx4 v2, s[32:35], s83 offen offset:2048 sc1 lds
  v_mfma_f32_16x16x32_bf16 v[56:59], v[120:123], a[168:171], v[56:59]
  ds_read_b128 v[104:107], v3 offset:63488
  v_cvt_pk_bf16_f32 v139, v22, v23
  v_mfma_f32_16x16x32_bf16 v[72:75], v[120:123], a[172:175], v[72:75]
  v_exp_f32 v128, v128
  v_mfma_f32_16x16x32_bf16 v[60:63], v[124:127], a[168:171], v[60:63]
  ds_read_b128 v[108:111], v3 offset:64512
  v_add_f32 v128, 1.0, v128
  v_mfma_f32_16x16x32_bf16 v[76:79], v[124:127], a[172:175], v[76:79]
  v_mul_f32 v129, s87, v33
  s_waitcnt lgkmcnt(4)
  v_mfma_f32_16x16x32_bf16 v[48:51], v[80:83], a[176:179], v[48:51]
  ds_read_b128 v[112:115], v4 offset:0
  ds_read_b128 v[116:119], v4 offset:1024
  v_mfma_f32_16x16x32_bf16 v[64:67], v[80:83], a[180:183], v[64:67]
  v_rcp_f32 v128, v128
  v_mfma_f32_16x16x32_bf16 v[52:55], v[84:87], a[176:179], v[52:55]
  ds_read_b128 v[120:123], v4 offset:2048
  v_mul_f32 v32, v32, v128
  v_mfma_f32_16x16x32_bf16 v[68:71], v[84:87], a[180:183], v[68:71]
  buffer_store_dwordx4 v[136:139], v2, s[32:35], s80 offen offset:0 sc1
  v_mfma_f32_16x16x32_bf16 v[56:59], v[88:91], a[176:179], v[56:59]
  ds_read_b128 v[124:127], v4 offset:3072
  v_mul_f32 v33, v33, v41
  v_mfma_f32_16x16x32_bf16 v[72:75], v[88:91], a[180:183], v[72:75]
  v_exp_f32 v129, v129
  v_mfma_f32_16x16x32_bf16 v[60:63], v[92:95], a[176:179], v[60:63]
  buffer_load_dwordx4 v2, s[32:35], s83 offen offset:3072 sc1 lds
  v_mfma_f32_16x16x32_bf16 v[76:79], v[92:95], a[180:183], v[76:79]
  v_add_f32 v129, 1.0, v129
  s_waitcnt lgkmcnt(4)
  v_mfma_f32_16x16x32_bf16 v[48:51], v[96:99], a[184:187], v[48:51]
  ds_read_b128 v[80:83], v4 offset:4096
  v_mul_f32 v130, s87, v34
  v_mfma_f32_16x16x32_bf16 v[64:67], v[96:99], a[188:191], v[64:67]
  v_rcp_f32 v129, v129
  v_mfma_f32_16x16x32_bf16 v[52:55], v[100:103], a[184:187], v[52:55]
  ds_read_b128 v[84:87], v4 offset:5120
  v_mul_f32 v33, v33, v129
  v_mfma_f32_16x16x32_bf16 v[68:71], v[100:103], a[188:191], v[68:71]
  s_add_u32 m0, m0, 16384
  s_add_u32 s83, s83, 16384
  buffer_load_dwordx4 v2, s[32:35], s83 offen offset:0 sc1 lds
  v_mfma_f32_16x16x32_bf16 v[56:59], v[104:107], a[184:187], v[56:59]
  ds_read_b128 v[88:91], v4 offset:6144
  v_cvt_pk_bf16_f32 v140, v32, v33
  v_mfma_f32_16x16x32_bf16 v[72:75], v[104:107], a[188:191], v[72:75]
  v_exp_f32 v130, v130
  v_mfma_f32_16x16x32_bf16 v[60:63], v[108:111], a[184:187], v[60:63]
  ds_read_b128 v[92:95], v4 offset:7168
  v_mul_f32 v34, v34, v42
  v_mfma_f32_16x16x32_bf16 v[76:79], v[108:111], a[188:191], v[76:79]
  v_add_f32 v130, 1.0, v130
  s_waitcnt lgkmcnt(4)
  v_mfma_f32_16x16x32_bf16 v[48:51], v[112:115], a[192:195], v[48:51]
  ds_read_b128 v[96:99], v4 offset:8192
  ds_read_b128 v[100:103], v4 offset:9216
  v_mfma_f32_16x16x32_bf16 v[64:67], v[112:115], a[196:199], v[64:67]
  v_rcp_f32 v130, v130
  v_mfma_f32_16x16x32_bf16 v[52:55], v[116:119], a[192:195], v[52:55]
  ds_read_b128 v[104:107], v4 offset:10240
  v_mul_f32 v34, v34, v130
  v_mfma_f32_16x16x32_bf16 v[68:71], v[116:119], a[196:199], v[68:71]
  buffer_load_dwordx4 v2, s[32:35], s83 offen offset:1024 sc1 lds
  v_mfma_f32_16x16x32_bf16 v[56:59], v[120:123], a[192:195], v[56:59]
  ds_read_b128 v[108:111], v4 offset:11264
  v_mul_f32 v131, s87, v35
  v_mfma_f32_16x16x32_bf16 v[72:75], v[120:123], a[196:199], v[72:75]
  v_exp_f32 v131, v131
  v_mfma_f32_16x16x32_bf16 v[60:63], v[124:127], a[192:195], v[60:63]
  buffer_load_dwordx4 v2, s[32:35], s83 offen offset:2048 sc1 lds
  v_mfma_f32_16x16x32_bf16 v[76:79], v[124:127], a[196:199], v[76:79]
  v_mul_f32 v35, v35, v43
  s_waitcnt lgkmcnt(4)
  v_mfma_f32_16x16x32_bf16 v[48:51], v[80:83], a[200:203], v[48:51]
  ds_read_b128 v[112:115], v4 offset:12288
  v_add_f32 v131, 1.0, v131
  v_mfma_f32_16x16x32_bf16 v[64:67], v[80:83], a[204:207], v[64:67]
  v_rcp_f32 v131, v131
  v_mfma_f32_16x16x32_bf16 v[52:55], v[84:87], a[200:203], v[52:55]
  ds_read_b128 v[116:119], v4 offset:13312
  v_mul_f32 v35, v35, v131
  v_mfma_f32_16x16x32_bf16 v[68:71], v[84:87], a[204:207], v[68:71]
  buffer_load_dwordx4 v2, s[32:35], s83 offen offset:3072 sc1 lds
  v_mfma_f32_16x16x32_bf16 v[56:59], v[88:91], a[200:203], v[56:59]
  ds_read_b128 v[120:123], v4 offset:14336
  v_cvt_pk_bf16_f32 v141, v34, v35
  v_mfma_f32_16x16x32_bf16 v[72:75], v[88:91], a[204:207], v[72:75]
  v_mul_f32 v128, s87, v36
  v_mul_f32 v129, s87, v37
  v_mfma_f32_16x16x32_bf16 v[60:63], v[92:95], a[200:203], v[60:63]
  ds_read_b128 v[124:127], v4 offset:15360
  v_mul_f32 v36, v36, v44
  v_mfma_f32_16x16x32_bf16 v[76:79], v[92:95], a[204:207], v[76:79]
  v_mul_f32 v37, v37, v45
  s_waitcnt lgkmcnt(4)
  v_mfma_f32_16x16x32_bf16 v[48:51], v[96:99], a[208:211], v[48:51]
  ds_read_b128 v[80:83], v4 offset:16384
  ds_read_b128 v[84:87], v4 offset:17408
  v_mfma_f32_16x16x32_bf16 v[64:67], v[96:99], a[212:215], v[64:67]
  v_exp_f32 v128, v128
  v_mfma_f32_16x16x32_bf16 v[52:55], v[100:103], a[208:211], v[52:55]
  ds_read_b128 v[88:91], v4 offset:18432
  v_add_f32 v128, 1.0, v128
  v_mfma_f32_16x16x32_bf16 v[68:71], v[100:103], a[212:215], v[68:71]
  buffer_load_dwordx4 a[92:95], v2, s[32:35], s88 offen offset:3072 sc1
  v_mfma_f32_16x16x32_bf16 v[56:59], v[104:107], a[208:211], v[56:59]
  ds_read_b128 v[92:95], v4 offset:19456
  v_mul_f32 v130, s87, v38
  v_mfma_f32_16x16x32_bf16 v[72:75], v[104:107], a[212:215], v[72:75]
  v_rcp_f32 v128, v128
  v_mfma_f32_16x16x32_bf16 v[60:63], v[108:111], a[208:211], v[60:63]
  s_add_u32 s88, s88, 4096
  buffer_load_dwordx4 v[160:163], v2, s[32:35], s88 offen offset:0 sc1
  v_mfma_f32_16x16x32_bf16 v[76:79], v[108:111], a[212:215], v[76:79]
  v_mul_f32 v36, v36, v128
  s_waitcnt lgkmcnt(4)
  v_mfma_f32_16x16x32_bf16 v[48:51], v[112:115], a[216:219], v[48:51]
  ds_read_b128 v[96:99], v4 offset:20480
  v_mul_f32 v38, v38, v46
  v_mfma_f32_16x16x32_bf16 v[64:67], v[112:115], a[220:223], v[64:67]
  v_exp_f32 v129, v129
  v_mfma_f32_16x16x32_bf16 v[52:55], v[116:119], a[216:219], v[52:55]
  ds_read_b128 v[100:103], v4 offset:21504
  v_add_f32 v129, 1.0, v129
  v_mfma_f32_16x16x32_bf16 v[68:71], v[116:119], a[220:223], v[68:71]
  s_add_u32 s88, s88, 11264
  buffer_load_dwordx4 v[164:167], v2, s[32:35], s88 offen offset:0 sc1
  v_mfma_f32_16x16x32_bf16 v[56:59], v[120:123], a[216:219], v[56:59]
  ds_read_b128 v[104:107], v4 offset:22528
  v_mul_f32 v131, s87, v39
  v_mfma_f32_16x16x32_bf16 v[72:75], v[120:123], a[220:223], v[72:75]
  v_rcp_f32 v129, v129
  v_mfma_f32_16x16x32_bf16 v[60:63], v[124:127], a[216:219], v[60:63]
  ds_read_b128 v[108:111], v4 offset:23552
  v_mul_f32 v37, v37, v129
  v_mfma_f32_16x16x32_bf16 v[76:79], v[124:127], a[220:223], v[76:79]
  v_cvt_pk_bf16_f32 v142, v36, v37
  s_waitcnt lgkmcnt(4)
  v_mfma_f32_16x16x32_bf16 v[48:51], v[80:83], a[224:227], v[48:51]
  ds_read_b128 v[112:115], v4 offset:24576
  ds_read_b128 v[116:119], v4 offset:25600
  v_mfma_f32_16x16x32_bf16 v[64:67], v[80:83], a[228:231], v[64:67]
  v_exp_f32 v130, v130
  v_mfma_f32_16x16x32_bf16 v[52:55], v[84:87], a[224:227], v[52:55]
  ds_read_b128 v[120:123], v4 offset:26624
  v_add_f32 v130, 1.0, v130
  v_mfma_f32_16x16x32_bf16 v[68:71], v[84:87], a[228:231], v[68:71]
  buffer_load_dwordx4 v[168:171], v2, s[32:35], s88 offen offset:1024 sc1
  v_mfma_f32_16x16x32_bf16 v[56:59], v[88:91], a[224:227], v[56:59]
  ds_read_b128 v[124:127], v4 offset:27648
  v_mul_f32 v39, v39, v47
  v_mfma_f32_16x16x32_bf16 v[72:75], v[88:91], a[228:231], v[72:75]
  v_rcp_f32 v130, v130
  v_mfma_f32_16x16x32_bf16 v[60:63], v[92:95], a[224:227], v[60:63]
  buffer_load_dwordx4 v[172:175], v2, s[32:35], s88 offen offset:2048 sc1
  v_mfma_f32_16x16x32_bf16 v[76:79], v[92:95], a[228:231], v[76:79]
  v_mul_f32 v38, v38, v130
  s_waitcnt lgkmcnt(4)
  v_mfma_f32_16x16x32_bf16 v[48:51], v[96:99], a[232:235], v[48:51]
  ds_read_b128 v[80:83], v4 offset:28672
  v_mfma_f32_16x16x32_bf16 v[64:67], v[96:99], a[236:239], v[64:67]
  v_exp_f32 v131, v131
  v_mfma_f32_16x16x32_bf16 v[52:55], v[100:103], a[232:235], v[52:55]
  ds_read_b128 v[84:87], v4 offset:29696
  v_add_f32 v131, 1.0, v131
  v_mfma_f32_16x16x32_bf16 v[68:71], v[100:103], a[236:239], v[68:71]
  buffer_load_dwordx4 v[176:179], v2, s[32:35], s88 offen offset:3072 sc1
  v_mfma_f32_16x16x32_bf16 v[56:59], v[104:107], a[232:235], v[56:59]
  ds_read_b128 v[88:91], v4 offset:30720
  v_mfma_f32_16x16x32_bf16 v[72:75], v[104:107], a[236:239], v[72:75]
  v_rcp_f32 v131, v131
  v_mfma_f32_16x16x32_bf16 v[60:63], v[108:111], a[232:235], v[60:63]
  ds_read_b128 v[92:95], v4 offset:31744
  v_mul_f32 v39, v39, v131
  v_mfma_f32_16x16x32_bf16 v[76:79], v[108:111], a[236:239], v[76:79]
  v_cvt_pk_bf16_f32 v143, v38, v39
  s_waitcnt lgkmcnt(4)
  s_waitcnt vmcnt(6)
  s_barrier
  v_mfma_f32_16x16x32_bf16 v[48:51], v[112:115], a[240:243], v[48:51]
  ds_read_b128 v[96:99], v2 offset:0
  ds_read_b128 v[100:103], v2 offset:1024
  v_mfma_f32_16x16x32_bf16 v[64:67], v[112:115], a[244:247], v[64:67]
  v_mfma_f32_16x16x32_bf16 v[52:55], v[116:119], a[240:243], v[52:55]
  ds_read_b128 v[104:107], v2 offset:2048
  v_mfma_f32_16x16x32_bf16 v[68:71], v[116:119], a[244:247], v[68:71]
  buffer_store_dwordx4 v[140:143], v2, s[32:35], s81 offen offset:0 sc1
  v_mfma_f32_16x16x32_bf16 v[56:59], v[120:123], a[240:243], v[56:59]
  ds_read_b128 v[108:111], v2 offset:3072
  v_mfma_f32_16x16x32_bf16 v[72:75], v[120:123], a[244:247], v[72:75]
  v_mfma_f32_16x16x32_bf16 v[60:63], v[124:127], a[240:243], v[60:63]
  s_add_u32 s88, s88, 4096
  buffer_load_dwordx4 v[180:183], v2, s[32:35], s88 offen offset:0 sc1
  v_mfma_f32_16x16x32_bf16 v[76:79], v[124:127], a[244:247], v[76:79]
  s_waitcnt lgkmcnt(4)
  v_mfma_f32_16x16x32_bf16 v[48:51], v[80:83], a[248:251], v[48:51]
  ds_read_b128 v[112:115], v2 offset:4096
  v_mfma_f32_16x16x32_bf16 v[64:67], v[80:83], a[252:255], v[64:67]
  v_mfma_f32_16x16x32_bf16 v[52:55], v[84:87], a[248:251], v[52:55]
  ds_read_b128 v[116:119], v2 offset:5120
  v_mfma_f32_16x16x32_bf16 v[68:71], v[84:87], a[252:255], v[68:71]
  s_add_u32 s88, s88, 11264
  buffer_load_dwordx4 v[184:187], v2, s[32:35], s88 offen offset:0 sc1
  v_mfma_f32_16x16x32_bf16 v[56:59], v[88:91], a[248:251], v[56:59]
  ds_read_b128 v[120:123], v2 offset:6144
  v_mfma_f32_16x16x32_bf16 v[72:75], v[88:91], a[252:255], v[72:75]
  v_mfma_f32_16x16x32_bf16 v[60:63], v[92:95], a[248:251], v[60:63]
  ds_read_b128 v[124:127], v2 offset:7168
  v_mfma_f32_16x16x32_bf16 v[76:79], v[92:95], a[252:255], v[76:79]
  s_waitcnt lgkmcnt(4)
  v_mfma_f32_16x16x32_bf16 v[16:19], v[96:99], a[96:99], 0
  ds_read_b128 v[80:83], v2 offset:8192
  ds_read_b128 v[84:87], v2 offset:9216
  v_mfma_f32_16x16x32_bf16 v[32:35], v[96:99], a[100:103], 0
  v_mfma_f32_16x16x32_bf16 v[20:23], v[100:103], a[96:99], 0
  ds_read_b128 v[88:91], v2 offset:10240
  v_mfma_f32_16x16x32_bf16 v[36:39], v[100:103], a[100:103], 0
  buffer_load_dwordx4 v[188:191], v2, s[32:35], s88 offen offset:1024 sc1
  v_mfma_f32_16x16x32_bf16 v[24:27], v[104:107], a[96:99], 0
  ds_read_b128 v[92:95], v2 offset:11264
  v_mfma_f32_16x16x32_bf16 v[40:43], v[104:107], a[100:103], 0
  v_mfma_f32_16x16x32_bf16 v[28:31], v[108:111], a[96:99], 0
  buffer_load_dwordx4 v[192:195], v2, s[32:35], s88 offen offset:2048 sc1
  v_mfma_f32_16x16x32_bf16 v[44:47], v[108:111], a[100:103], 0
  v_mul_f32 v128, s87, v48
  s_waitcnt lgkmcnt(4)
  v_mfma_f32_16x16x32_bf16 v[16:19], v[112:115], a[104:107], v[16:19]
  ds_read_b128 v[96:99], v2 offset:12288
  v_mul_f32 v48, v48, v56
  v_mfma_f32_16x16x32_bf16 v[32:35], v[112:115], a[108:111], v[32:35]
  v_exp_f32 v128, v128
  v_mfma_f32_16x16x32_bf16 v[20:23], v[116:119], a[104:107], v[20:23]
  ds_read_b128 v[100:103], v2 offset:13312
  v_add_f32 v128, 1.0, v128
  v_mfma_f32_16x16x32_bf16 v[36:39], v[116:119], a[108:111], v[36:39]
  buffer_load_dwordx4 v[196:199], v2, s[32:35], s88 offen offset:3072 sc1
  v_mfma_f32_16x16x32_bf16 v[24:27], v[120:123], a[104:107], v[24:27]
  ds_read_b128 v[104:107], v2 offset:14336
  v_mul_f32 v129, s87, v49
  v_mfma_f32_16x16x32_bf16 v[40:43], v[120:123], a[108:111], v[40:43]
  v_rcp_f32 v128, v128
  v_mfma_f32_16x16x32_bf16 v[28:31], v[124:127], a[104:107], v[28:31]
  ds_read_b128 v[108:111], v2 offset:15360
  v_mul_f32 v48, v48, v128
  v_mfma_f32_16x16x32_bf16 v[44:47], v[124:127], a[108:111], v[44:47]
  v_mul_f32 v49, v49, v57
  s_waitcnt lgkmcnt(4)
  v_mfma_f32_16x16x32_bf16 v[16:19], v[80:83], a[112:115], v[16:19]
  ds_read_b128 v[112:115], v2 offset:16384
  ds_read_b128 v[116:119], v2 offset:17408
  v_mfma_f32_16x16x32_bf16 v[32:35], v[80:83], a[116:119], v[32:35]
  v_exp_f32 v129, v129
  v_mfma_f32_16x16x32_bf16 v[20:23], v[84:87], a[112:115], v[20:23]
  ds_read_b128 v[120:123], v2 offset:18432
  v_add_f32 v129, 1.0, v129
  v_mfma_f32_16x16x32_bf16 v[36:39], v[84:87], a[116:119], v[36:39]
  s_add_u32 s88, s88, 4096
  buffer_load_dwordx4 v[200:203], v2, s[32:35], s88 offen offset:0 sc1
  v_mfma_f32_16x16x32_bf16 v[24:27], v[88:91], a[112:115], v[24:27]
  ds_read_b128 v[124:127], v2 offset:19456
  v_mul_f32 v130, s87, v50
  v_mfma_f32_16x16x32_bf16 v[40:43], v[88:91], a[116:119], v[40:43]
  v_rcp_f32 v129, v129
  v_mfma_f32_16x16x32_bf16 v[28:31], v[92:95], a[112:115], v[28:31]
  s_add_u32 s88, s88, 11264
  buffer_load_dwordx4 v[204:207], v2, s[32:35], s88 offen offset:0 sc1
  v_mfma_f32_16x16x32_bf16 v[44:47], v[92:95], a[116:119], v[44:47]
  v_mul_f32 v49, v49, v129
  s_waitcnt lgkmcnt(4)
  v_mfma_f32_16x16x32_bf16 v[16:19], v[96:99], a[120:123], v[16:19]
  ds_read_b128 v[80:83], v2 offset:20480
  v_cvt_pk_bf16_f32 v136, v48, v49
  v_mfma_f32_16x16x32_bf16 v[32:35], v[96:99], a[124:127], v[32:35]
  v_exp_f32 v130, v130
  v_mfma_f32_16x16x32_bf16 v[20:23], v[100:103], a[120:123], v[20:23]
  ds_read_b128 v[84:87], v2 offset:21504
  v_mul_f32 v50, v50, v58
  v_mfma_f32_16x16x32_bf16 v[36:39], v[100:103], a[124:127], v[36:39]
  buffer_load_dwordx4 v[208:211], v2, s[32:35], s88 offen offset:1024 sc1
  v_mfma_f32_16x16x32_bf16 v[24:27], v[104:107], a[120:123], v[24:27]
  ds_read_b128 v[88:91], v2 offset:22528
  v_add_f32 v130, 1.0, v130
  v_mfma_f32_16x16x32_bf16 v[40:43], v[104:107], a[124:127], v[40:43]
  v_rcp_f32 v130, v130
  v_mfma_f32_16x16x32_bf16 v[28:31], v[108:111], a[120:123], v[28:31]
  ds_read_b128 v[92:95], v2 offset:23552
  v_mul_f32 v50, v50, v130
  v_mfma_f32_16x16x32_bf16 v[44:47], v[108:111], a[124:127], v[44:47]
  v_mul_f32 v131, s87, v51
  s_waitcnt lgkmcnt(4)
  s_waitcnt vmcnt(8)
  s_barrier
  s_cmp_eq_u32 s3, 0
  s_cbranch_scc0 AS_60
  s_mov_b64 exec, 15
  buffer_store_dword v235, v229, s[32:35], s85 offen offset:0 sc1
  s_mov_b64 exec, -1
AS_60:
  v_mfma_f32_16x16x32_bf16 v[16:19], v[112:115], a[128:131], v[16:19]
  ds_read_b128 v[96:99], v2 offset:24576
  ds_read_b128 v[100:103], v2 offset:25600
  v_mfma_f32_16x16x32_bf16 v[32:35], v[112:115], a[132:135], v[32:35]
  v_exp_f32 v131, v131
  v_mfma_f32_16x16x32_bf16 v[20:23], v[116:119], a[128:131], v[20:23]
  ds_read_b128 v[104:107], v2 offset:26624
  v_mul_f32 v51, v51, v59
  v_mfma_f32_16x16x32_bf16 v[36:39], v[116:119], a[132:135], v[36:39]
  buffer_load_dwordx4 v[212:215], v2, s[32:35], s88 offen offset:2048 sc1
  v_mfma_f32_16x16x32_bf16 v[24:27], v[120:123], a[128:131], v[24:27]
  ds_read_b128 v[108:111], v2 offset:27648
  v_add_f32 v131, 1.0, v131
  v_mfma_f32_16x16x32_bf16 v[40:43], v[120:123], a[132:135], v[40:43]
  v_rcp_f32 v131, v131
  v_mfma_f32_16x16x32_bf16 v[28:31], v[124:127], a[128:131], v[28:31]
  buffer_load_dwordx4 v[216:219], v2, s[32:35], s88 offen offset:3072 sc1
  v_mfma_f32_16x16x32_bf16 v[44:47], v[124:127], a[132:135], v[44:47]
  v_mul_f32 v51, v51, v131
  s_waitcnt lgkmcnt(4)
  v_mfma_f32_16x16x32_bf16 v[16:19], v[80:83], a[136:139], v[16:19]
  ds_read_b128 v[112:115], v2 offset:28672
  v_cvt_pk_bf16_f32 v137, v50, v51
  v_mfma_f32_16x16x32_bf16 v[32:35], v[80:83], a[140:143], v[32:35]
  v_mul_f32 v128, s87, v52
  v_mul_f32 v129, s87, v53
  v_mfma_f32_16x16x32_bf16 v[20:23], v[84:87], a[136:139], v[20:23]
  ds_read_b128 v[116:119], v2 offset:29696
  v_mul_f32 v52, v52, v60
  v_mfma_f32_16x16x32_bf16 v[36:39], v[84:87], a[140:143], v[36:39]
  s_add_u32 s88, s88, 4096
  buffer_load_dwordx4 v[220:223], v2, s[32:35], s88 offen offset:0 sc1
  v_mfma_f32_16x16x32_bf16 v[24:27], v[88:91], a[136:139], v[24:27]
  ds_read_b128 v[120:123], v2 offset:30720
  v_mul_f32 v53, v53, v61
  v_mfma_f32_16x16x32_bf16 v[40:43], v[88:91], a[140:143], v[40:43]
  v_exp_f32 v128, v128
  v_mfma_f32_16x16x32_bf16 v[28:31], v[92:95], a[136:139], v[28:31]
  ds_read_b128 v[124:127], v2 offset:31744
  v_add_f32 v128, 1.0, v128
  v_mfma_f32_16x16x32_bf16 v[44:47], v[92:95], a[140:143], v[44:47]
  v_mul_f32 v130, s87, v54
  s_waitcnt lgkmcnt(4)
  v_mfma_f32_16x16x32_bf16 v[16:19], v[96:99], a[144:147], v[16:19]
  ds_read_b128 v[80:83], v2 offset:32768
  ds_read_b128 v[84:87], v2 offset:33792
  v_mfma_f32_16x16x32_bf16 v[32:35], v[96:99], a[148:151], v[32:35]
  v_rcp_f32 v128, v128
  v_mfma_f32_16x16x32_bf16 v[20:23], v[100:103], a[144:147], v[20:23]
  ds_read_b128 v[88:91], v2 offset:34816
  v_mul_f32 v52, v52, v128
  v_mfma_f32_16x16x32_bf16 v[36:39], v[100:103], a[148:151], v[36:39]
  s_sub_u32 s88, s88, 45056
  buffer_load_dwordx4 a[96:99], v2, s[32:35], s88 offen offset:0 sc1
  v_mfma_f32_16x16x32_bf16 v[24:27], v[104:107], a[144:147], v[24:27]
  ds_read_b128 v[92:95], v2 offset:35840
  v_mul_f32 v54, v54, v62
  v_mfma_f32_16x16x32_bf16 v[40:43], v[104:107], a[148:151], v[40:43]
  v_exp_f32 v129, v129
  v_mfma_f32_16x16x32_bf16 v[28:31], v[108:111], a[144:147], v[28:31]
  buffer_load_dwordx4 a[100:103], v2, s[32:35], s88 offen offset:1024 sc1
  v_mfma_f32_16x16x32_bf16 v[44:47], v[108:111], a[148:151], v[44:47]
  v_add_f32 v129, 1.0, v129
  s_waitcnt lgkmcnt(4)
  v_mfma_f32_16x16x32_bf16 v[16:19], v[112:115], a[152:155], v[16:19]
  ds_read_b128 v[96:99], v2 offset:36864
  v_mul_f32 v131, s87, v55
  v_mfma_f32_16x16x32_bf16 v[32:35], v[112:115], a[156:159], v[32:35]
  v_rcp_f32 v129, v129
  v_mfma_f32_16x16x32_bf16 v[20:23], v[116:119], a[152:155], v[20:23]
  ds_read_b128 v[100:103], v2 offset:37888
  v_mul_f32 v53, v53, v129
  v_mfma_f32_16x16x32_bf16 v[36:39], v[116:119], a[156:159], v[36:39]
  buffer_load_dwordx4 a[104:107], v2, s[32:35], s88 offen offset:2048 sc1
  v_mfma_f32_16x16x32_bf16 v[24:27], v[120:123], a[152:155], v[24:27]
  ds_read_b128 v[104:107], v2 offset:38912
  v_cvt_pk_bf16_f32 v138, v52, v53
  v_mfma_f32_16x16x32_bf16 v[40:43], v[120:123], a[156:159], v[40:43]
  v_exp_f32 v130, v130
  v_mfma_f32_16x16x32_bf16 v[28:31], v[124:127], a[152:155], v[28:31]
  ds_read_b128 v[108:111], v2 offset:39936
  v_add_f32 v130, 1.0, v130
  v_mfma_f32_16x16x32_bf16 v[44:47], v[124:127], a[156:159], v[44:47]
  v_mul_f32 v55, v55, v63
  s_waitcnt lgkmcnt(4)
  v_mfma_f32_16x16x32_bf16 v[16:19], v[80:83], a[160:163], v[16:19]
  ds_read_b128 v[112:115], v2 offset:40960
  ds_read_b128 v[116:119], v2 offset:41984
  v_mfma_f32_16x16x32_bf16 v[32:35], v[80:83], a[164:167], v[32:35]
  v_rcp_f32 v130, v130
  v_mfma_f32_16x16x32_bf16 v[20:23], v[84:87], a[160:163], v[20:23]
  ds_read_b128 v[120:123], v2 offset:43008
  v_mul_f32 v54, v54, v130
  v_mfma_f32_16x16x32_bf16 v[36:39], v[84:87], a[164:167], v[36:39]
  buffer_load_dwordx4 a[108:111], v2, s[32:35], s88 offen offset:3072 sc1
  v_mfma_f32_16x16x32_bf16 v[24:27], v[88:91], a[160:163], v[24:27]
  ds_read_b128 v[124:127], v2 offset:44032
  v_mul_f32 v128, s87, v64
  v_mfma_f32_16x16x32_bf16 v[40:43], v[88:91], a[164:167], v[40:43]
  v_exp_f32 v131, v131
  v_mfma_f32_16x16x32_bf16 v[28:31], v[92:95], a[160:163], v[28:31]
  s_add_u32 s88, s88, 4096
  buffer_load_dwordx4 a[112:115], v2, s[32:35], s88 offen offset:0 sc1
  v_mfma_f32_16x16x32_bf16 v[44:47], v[92:95], a[164:167], v[44:47]
  v_add_f32 v131, 1.0, v131
  s_waitcnt lgkmcnt(4)
  v_mfma_f32_16x16x32_bf16 v[16:19], v[96:99], a[168:171], v[16:19]
  ds_read_b128 v[80:83], v2 offset:45056
  v_mul_f32 v64, v64, v72
  v_mfma_f32_16x16x32_bf16 v[32:35], v[96:99], a[172:175], v[32:35]
  v_rcp_f32 v131, v131
  v_mfma_f32_16x16x32_bf16 v[20:23], v[100:103], a[168:171], v[20:23]
  ds_read_b128 v[84:87], v2 offset:46080
  v_mul_f32 v55, v55, v131
  v_mfma_f32_16x16x32_bf16 v[36:39], v[100:103], a[172:175], v[36:39]
  s_add_u32 s88, s88, 11264
  buffer_load_dwordx4 a[116:119], v2, s[32:35], s88 offen offset:0 sc1
  v_mfma_f32_16x16x32_bf16 v[24:27], v[104:107], a[168:171], v[24:27]
  ds_read_b128 v[88:91], v2 offset:47104
  v_cvt_pk_bf16_f32 v139, v54, v55
  v_mfma_f32_16x16x32_bf16 v[40:43], v[104:107], a[172:175], v[40:43]
  v_exp_f32 v128, v128
  v_mfma_f32_16x16x32_bf16 v[28:31], v[108:111], a[168:171], v[28:31]
  ds_read_b128 v[92:95], v2 offset:48128
  v_add_f32 v128, 1.0, v128
  v_mfma_f32_16x16x32_bf16 v[44:47], v[108:111], a[172:175], v[44:47]
  v_mul_f32 v129, s87, v65
  s_waitcnt lgkmcnt(4)
  v_mfma_f32_16x16x32_bf16 v[16:19], v[112:115], a[176:179], v[16:19]
  ds_read_b128 v[96:99], v2 offset:49152
  ds_read_b128 v[100:103], v2 offset:50176
  v_mfma_f32_16x16x32_bf16 v[32:35], v[112:115], a[180:183], v[32:35]
  v_rcp_f32 v128, v128
  v_mfma_f32_16x16x32_bf16 v[20:23], v[116:119], a[176:179], v[20:23]
  ds_read_b128 v[104:107], v2 offset:51200
  v_mul_f32 v64, v64, v128
  v_mfma_f32_16x16x32_bf16 v[36:39], v[116:119], a[180:183], v[36:39]
  buffer_store_dwordx4 v[136:139], v2, s[32:35], s80 offen offset:1024 sc1
  v_mfma_f32_16x16x32_bf16 v[24:27], v[120:123], a[176:179], v[24:27]
  ds_read_b128 v[108:111], v2 offset:52224
  v_mul_f32 v65, v65, v73
  v_mfma_f32_16x16x32_bf16 v[40:43], v[120:123], a[180:183], v[40:43]
  v_exp_f32 v129, v129
  v_mfma_f32_16x16x32_bf16 v[28:31], v[124:127], a[176:179], v[28:31]
  buffer_load_dwordx4 a[120:123], v2, s[32:35], s88 offen offset:1024 sc1
  v_mfma_f32_16x16x32_bf16 v[44:47], v[124:127], a[180:183], v[44:47]
  v_add_f32 v129, 1.0, v129
  s_waitcnt lgkmcnt(4)
  v_mfma_f32_16x16x32_bf16 v[16:19], v[80:83], a[184:187], v[16:19]
  ds_read_b128 v[112:115], v2 offset:53248
  v_mul_f32 v130, s87, v66
  v_mfma_f32_16x16x32_bf16 v[32:35], v[80:83], a[188:191], v[32:35]
  v_rcp_f32 v129, v129
  v_mfma_f32_16x16x32_bf16 v[20:23], v[84:87], a[184:187], v[20:23]
  ds_read_b128 v[116:119], v2 offset:54272
  v_mul_f32 v65, v65, v129
  v_mfma_f32_16x16x32_bf16 v[36:39], v[84:87], a[188:191], v[36:39]
  buffer_load_dwordx4 a[124:127], v2, s[32:35], s88 offen offset:2048 sc1
  v_mfma_f32_16x16x32_bf16 v[24:27], v[88:91], a[184:187], v[24:27]
  ds_read_b128 v[120:123], v2 offset:55296
  v_cvt_pk_bf16_f32 v140, v64, v65
  v_mfma_f32_16x16x32_bf16 v[40:43], v[88:91], a[188:191], v[40:43]
  v_exp_f32 v130, v130
  v_mfma_f32_16x16x32_bf16 v[28:31], v[92:95], a[184:187], v[28:31]
  ds_read_b128 v[124:127], v2 offset:56320
  v_mul_f32 v66, v66, v74
  v_mfma_f32_16x16x32_bf16 v[44:47], v[92:95], a[188:191], v[44:47]
  v_add_f32 v130, 1.0, v130
  s_waitcnt lgkmcnt(4)
  v_mfma_f32_16x16x32_bf16 v[16:19], v[96:99], a[192:195], v[16:19]
  ds_read_b128 v[80:83], v2 offset:57344
  ds_read_b128 v[84:87], v2 offset:58368
  v_mfma_f32_16x16x32_bf16 v[32:35], v[96:99], a[196:199], v[32:35]
  v_rcp_f32 v130, v130
  v_mfma_f32_16x16x32_bf16 v[20:23], v[100:103], a[192:195], v[20:23]
  ds_read_b128 v[88:91], v2 offset:59392
  v_mul_f32 v66, v66, v130
  v_mfma_f32_16x16x32_bf16 v[36:39], v[100:103], a[196:199], v[36:39]
  buffer_load_dwordx4 a[128:131], v2, s[32:35], s88 offen offset:3072 sc1
  v_mfma_f32_16x16x32_bf16 v[24:27], v[104:107], a[192:195], v[24:27]
  ds_read_b128 v[92:95], v2 offset:60416
  v_mul_f32 v131, s87, v67
  v_mfma_f32_16x16x32_bf16 v[40:43], v[104:107], a[196:199], v[40:43]
  v_exp_f32 v131, v131
  v_mfma_f32_16x16x32_bf16 v[28:31], v[108:111], a[192:195], v[28:31]
  s_add_u32 s88, s88, 4096
  buffer_load_dwordx4 a[132:135], v2, s[32:35], s88 offen offset:0 sc1
  v_mfma_f32_16x16x32_bf16 v[44:47], v[108:111], a[196:199], v[44:47]
  v_mul_f32 v67, v67, v75
  s_waitcnt lgkmcnt(4)
  v_mfma_f32_16x16x32_bf16 v[16:19], v[112:115], a[200:203], v[16:19]
  ds_read_b128 v[96:99], v2 offset:61440
  v_add_f32 v131, 1.0, v131
  v_mfma_f32_16x16x32_bf16 v[32:35], v[112:115], a[204:207], v[32:35]
  v_rcp_f32 v131, v131
  v_mfma_f32_16x16x32_bf16 v[20:23], v[116:119], a[200:203], v[20:23]
  ds_read_b128 v[100:103], v2 offset:62464
  v_mul_f32 v67, v67, v131
  v_mfma_f32_16x16x32_bf16 v[36:39], v[116:119], a[204:207], v[36:39]
  s_add_u32 s88, s88, 11264
  buffer_load_dwordx4 a[136:139], v2, s[32:35], s88 offen offset:0 sc1
  v_mfma_f32_16x16x32_bf16 v[24:27], v[120:123], a[200:203], v[24:27]
  ds_read_b128 v[104:107], v2 offset:63488
  v_cvt_pk_bf16_f32 v141, v66, v67
  v_mfma_f32_16x16x32_bf16 v[40:43], v[120:123], a[204:207], v[40:43]
  v_mul_f32 v128, s87, v68
  v_mul_f32 v129, s87, v69
  v_mfma_f32_16x16x32_bf16 v[28:31], v[124:127], a[200:203], v[28:31]
  ds_read_b128 v[108:111], v2 offset:64512
  v_mul_f32 v68, v68, v76
  v_mfma_f32_16x16x32_bf16 v[44:47], v[124:127], a[204:207], v[44:47]
  v_mul_f32 v69, v69, v77
  s_waitcnt lgkmcnt(4)
  v_mfma_f32_16x16x32_bf16 v[16:19], v[80:83], a[208:211], v[16:19]
  ds_read_b128 v[112:115], v3 offset:0
  ds_read_b128 v[116:119], v3 offset:1024
  v_mfma_f32_16x16x32_bf16 v[32:35], v[80:83], a[212:215], v[32:35]
  v_exp_f32 v128, v128
  v_mfma_f32_16x16x32_bf16 v[20:23], v[84:87], a[208:211], v[20:23]
  ds_read_b128 v[120:123], v3 offset:2048
  v_add_f32 v128, 1.0, v128
  v_mfma_f32_16x16x32_bf16 v[36:39], v[84:87], a[212:215], v[36:39]
  buffer_load_dwordx4 a[140:143], v2, s[32:35], s88 offen offset:1024 sc1
  v_mfma_f32_16x16x32_bf16 v[24:27], v[88:91], a[208:211], v[24:27]
  ds_read_b128 v[124:127], v3 offset:3072
  v_mul_f32 v130, s87, v70
  v_mfma_f32_16x16x32_bf16 v[40:43], v[88:91], a[212:215], v[40:43]
  v_rcp_f32 v128, v128
  v_mfma_f32_16x16x32_bf16 v[28:31], v[92:95], a[208:211], v[28:31]
  buffer_load_dwordx4 a[144:147], v2, s[32:35], s88 offen offset:2048 sc1
  v_mfma_f32_16x16x32_bf16 v[44:47], v[92:95], a[212:215], v[44:47]
  v_mul_f32 v68, v68, v128
  s_waitcnt lgkmcnt(4)
  v_mfma_f32_16x16x32_bf16 v[16:19], v[96:99], a[216:219], v[16:19]
  ds_read_b128 v[80:83], v3 offset:4096
  ds_read_b128 v[84:87], v3 offset:5120
  v_mfma_f32_16x16x32_bf16 v[32:35], v[96:99], a[220:223], v[32:35]
  v_exp_f32 v129, v129
  v_mfma_f32_16x16x32_bf16 v[20:23], v[100:103], a[216:219], v[20:23]
  ds_read_b128 v[88:91], v3 offset:6144
  v_add_f32 v129, 1.0, v129
  v_mfma_f32_16x16x32_bf16 v[36:39], v[100:103], a[220:223], v[36:39]
  buffer_load_dwordx4 a[148:151], v2, s[32:35], s88 offen offset:3072 sc1
  v_mfma_f32_16x16x32_bf16 v[24:27], v[104:107], a[216:219], v[24:27]
  ds_read_b128 v[92:95], v3 offset:7168
  v_mul_f32 v70, v70, v78
  v_mfma_f32_16x16x32_bf16 v[40:43], v[104:107], a[220:223], v[40:43]
  v_rcp_f32 v129, v129
  v_mfma_f32_16x16x32_bf16 v[28:31], v[108:111], a[216:219], v[28:31]
  buffer_load_dword v224, v14, s[32:35], s84 offen offset:0 sc1
  v_mfma_f32_16x16x32_bf16 v[44:47], v[108:111], a[220:223], v[44:47]
  v_mul_f32 v69, v69, v129
  s_waitcnt lgkmcnt(4)
  v_mfma_f32_16x16x32_bf16 v[16:19], v[112:115], a[224:227], v[16:19]
  ds_read_b128 v[96:99], v3 offset:8192
  ds_read_b128 v[100:103], v3 offset:9216
  v_mfma_f32_16x16x32_bf16 v[32:35], v[112:115], a[228:231], v[32:35]
  v_cvt_pk_bf16_f32 v142, v68, v69
  v_mul_f32 v131, s87, v71
  v_mfma_f32_16x16x32_bf16 v[20:23], v[116:119], a[224:227], v[20:23]
  ds_read_b128 v[104:107], v3 offset:10240
  v_mul_f32 v71, v71, v79
  v_mfma_f32_16x16x32_bf16 v[36:39], v[116:119], a[228:231], v[36:39]
  s_add_u32 s88, s88, 4096
  buffer_load_dwordx4 a[152:155], v2, s[32:35], s88 offen offset:0 sc1
  v_mfma_f32_16x16x32_bf16 v[24:27], v[120:123], a[224:227], v[24:27]
  ds_read_b128 v[108:111], v3 offset:11264
  v_mfma_f32_16x16x32_bf16 v[40:43], v[120:123], a[228:231], v[40:43]
  v_exp_f32 v130, v130
  v_mfma_f32_16x16x32_bf16 v[28:31], v[124:127], a[224:227], v[28:31]
  s_add_u32 s88, s88, 11264
  buffer_load_dwordx4 a[156:159], v2, s[32:35], s88 offen offset:0 sc1
  v_mfma_f32_16x16x32_bf16 v[44:47], v[124:127], a[228:231], v[44:47]
  v_add_f32 v130, 1.0, v130
  s_waitcnt lgkmcnt(4)
  v_mfma_f32_16x16x32_bf16 v[16:19], v[80:83], a[232:235], v[16:19]
  ds_read_b128 v[112:115], v3 offset:12288
  v_mfma_f32_16x16x32_bf16 v[32:35], v[80:83], a[236:239], v[32:35]
  v_rcp_f32 v130, v130
  v_mfma_f32_16x16x32_bf16 v[20:23], v[84:87], a[232:235], v[20:23]
  ds_read_b128 v[116:119], v3 offset:13312
  v_mul_f32 v70, v70, v130
  v_mfma_f32_16x16x32_bf16 v[36:39], v[84:87], a[236:239], v[36:39]
  buffer_load_dwordx4 a[160:163], v2, s[32:35], s88 offen offset:1024 sc1
  v_mfma_f32_16x16x32_bf16 v[24:27], v[88:91], a[232:235], v[24:27]
  ds_read_b128 v[120:123], v3 offset:14336
  v_mfma_f32_16x16x32_bf16 v[40:43], v[88:91], a[236:239], v[40:43]
  v_exp_f32 v131, v131
  v_mfma_f32_16x16x32_bf16 v[28:31], v[92:95], a[232:235], v[28:31]
  ds_read_b128 v[124:127], v3 offset:15360
  v_add_f32 v131, 1.0, v131
  v_mfma_f32_16x16x32_bf16 v[44:47], v[92:95], a[236:239], v[44:47]
  s_waitcnt lgkmcnt(4)
  v_mfma_f32_16x16x32_bf16 v[16:19], v[96:99], a[240:243], v[16:19]
  v_rcp_f32 v131, v131
  v_mfma_f32_16x16x32_bf16 v[32:35], v[96:99], a[244:247], v[32:35]
  v_mul_f32 v71, v71, v131
  v_mfma_f32_16x16x32_bf16 v[20:23], v[100:103], a[240:243], v[20:23]
  v_cvt_pk_bf16_f32 v143, v70, v71
  v_mfma_f32_16x16x32_bf16 v[36:39], v[100:103], a[244:247], v[36:39]
  buffer_load_dwordx4 a[164:167], v2, s[32:35], s88 offen offset:2048 sc1
  v_mfma_f32_16x16x32_bf16 v[24:27], v[104:107], a[240:243], v[24:27]
  v_mfma_f32_16x16x32_bf16 v[40:43], v[104:107], a[244:247], v[40:43]
  v_mfma_f32_16x16x32_bf16 v[28:31], v[108:111], a[240:243], v[28:31]
  buffer_load_dwordx4 a[168:171], v2, s[32:35], s88 offen offset:3072 sc1
  v_mfma_f32_16x16x32_bf16 v[44:47], v[108:111], a[244:247], v[44:47]
  s_waitcnt lgkmcnt(0)
  v_mfma_f32_16x16x32_bf16 v[16:19], v[112:115], a[248:251], v[16:19]
  v_mfma_f32_16x16x32_bf16 v[32:35], v[112:115], a[252:255], v[32:35]
  v_mfma_f32_16x16x32_bf16 v[20:23], v[116:119], a[248:251], v[20:23]
  v_mfma_f32_16x16x32_bf16 v[36:39], v[116:119], a[252:255], v[36:39]
  buffer_store_dwordx4 v[140:143], v2, s[32:35], s81 offen offset:1024 sc1
  v_mfma_f32_16x16x32_bf16 v[24:27], v[120:123], a[248:251], v[24:27]
  v_mfma_f32_16x16x32_bf16 v[40:43], v[120:123], a[252:255], v[40:43]
  v_mfma_f32_16x16x32_bf16 v[28:31], v[124:127], a[248:251], v[28:31]
  v_mfma_f32_16x16x32_bf16 v[44:47], v[124:127], a[252:255], v[44:47]
  s_waitcnt vmcnt(6)
  v_cmp_ne_u32 vcc, s4, v224
  s_add_u32 s7, s84, 0
  s_cbranch_vccz FOK_61
  s_mov_b64 exec, vcc
  s_movk_i32 s5, 0
POLL_62:
  buffer_load_dword v15, v14, s[32:35], s7 offen sc1
  s_addk_i32 s5, 1
  s_waitcnt vmcnt(0)
  v_cmp_ne_u32 vcc, s4, v15
  s_cmpk_ge_u32 s5, 20000
  s_cbranch_scc1 POLLX_63
  s_cbranch_vccz POLLX_63
  s_mov_b64 exec, vcc
  s_sleep 2
  s_branch POLL_62
POLLX_63:
  s_mov_b64 exec, -1
FOK_61:
  v_mov_b32 v230, s87
  v_mov_b32 v231, 1.0
  v_pk_mul_f32 v[144:145], v[230:231], v[16:17] op_sel_hi:[0,1]
  v_pk_mul_f32 v[146:147], v[230:231], v[18:19] op_sel_hi:[0,1]
  v_pk_mul_f32 v[148:149], v[230:231], v[20:21] op_sel_hi:[0,1]
  s_add_u32 s88, s88, 4096
  buffer_load_dwordx4 a[172:175], v2, s[32:35], s88 offen offset:0 sc1
  v_pk_mul_f32 v[150:151], v[230:231], v[22:23] op_sel_hi:[0,1]
  v_exp_f32 v144, v144
  v_exp_f32 v145, v145
  v_exp_f32 v146, v146
  v_exp_f32 v147, v147
  v_exp_f32 v148, v148
  v_exp_f32 v149, v149
  v_exp_f32 v150, v150
  v_exp_f32 v151, v151
  buffer_load_dwordx4 a[176:179], v2, s[32:35], s68 offen offset:0 sc1
  v_pk_mul_f32 v[16:17], v[16:17], v[24:25]
  v_pk_mul_f32 v[18:19], v[18:19], v[26:27]
  v_pk_mul_f32 v[20:21], v[20:21], v[28:29]
  v_pk_mul_f32 v[22:23], v[22:23], v[30:31]
  v_pk_add_f32 v[144:145], v[230:231], v[144:145] op_sel:[1,0]
  v_pk_add_f32 v[146:147], v[230:231], v[146:147] op_sel:[1,0]
  v_pk_add_f32 v[148:149], v[230:231], v[148:149] op_sel:[1,0]
  v_pk_add_f32 v[150:151], v[230:231], v[150:151] op_sel:[1,0]
  v_rcp_f32 v144, v144
  buffer_load_dwordx4 a[180:183], v2, s[32:35], s68 offen offset:3072 sc1
  v_rcp_f32 v145, v145
  v_rcp_f32 v146, v146
  v_rcp_f32 v147, v147
  v_rcp_f32 v148, v148
  v_rcp_f32 v149, v149
  v_rcp_f32 v150, v150
  v_rcp_f32 v151, v151
  v_pk_mul_f32 v[16:17], v[16:17], v[144:145]
  v_pk_mul_f32 v[18:19], v[18:19], v[146:147]
  buffer_load_dwordx4 a[184:187], v2, s[32:35], s72 offen offset:0 sc1
  v_pk_mul_f32 v[20:21], v[20:21], v[148:149]
  v_pk_mul_f32 v[22:23], v[22:23], v[150:151]
  v_cvt_pk_bf16_f32 v152, v16, v17
  v_cvt_pk_bf16_f32 v153, v18, v19
  v_cvt_pk_bf16_f32 v154, v20, v21
  v_cvt_pk_bf16_f32 v155, v22, v23
  s_waitcnt vmcnt(4)
  s_barrier
  s_cmp_eq_u32 s3, 0
  s_cbranch_scc0 AS_64
  s_mov_b64 exec, 15
  buffer_store_dword v235, v229, s[32:35], s85 offen offset:128 sc1
  s_mov_b64 exec, -1
AS_64:
  v_pk_mul_f32 v[144:145], v[230:231], v[32:33] op_sel_hi:[0,1]
  v_pk_mul_f32 v[146:147], v[230:231], v[34:35] op_sel_hi:[0,1]
  v_pk_mul_f32 v[148:149], v[230:231], v[36:37] op_sel_hi:[0,1]
  buffer_load_dwordx4 a[188:191], v2, s[32:35], s72 offen offset:3072 sc1
  v_pk_mul_f32 v[150:151], v[230:231], v[38:39] op_sel_hi:[0,1]
  v_exp_f32 v144, v144
  v_exp_f32 v145, v145
  v_exp_f32 v146, v146
  v_exp_f32 v147, v147
  v_exp_f32 v148, v148
  v_exp_f32 v149, v149
  v_exp_f32 v150, v150
  v_exp_f32 v151, v151
  buffer_load_dwordx4 a[192:195], v2, s[32:35], s69 offen offset:0 sc1
  v_pk_mul_f32 v[32:33], v[32:33], v[40:41]
  v_pk_mul_f32 v[34:35], v[34:35], v[42:43]
  v_pk_mul_f32 v[36:37], v[36:37], v[44:45]
  v_pk_mul_f32 v[38:39], v[38:39], v[46:47]
  v_pk_add_f32 v[144:145], v[230:231], v[144:145] op_sel:[1,0]
  v_pk_add_f32 v[146:147], v[230:231], v[146:147] op_sel:[1,0]
  v_pk_add_f32 v[148:149], v[230:231], v[148:149] op_sel:[1,0]
  v_pk_add_f32 v[150:151], v[230:231], v[150:151] op_sel:[1,0]
  v_rcp_f32 v144, v144
  buffer_load_dwordx4 a[196:199], v2, s[32:35], s69 offen offset:3072 sc1
  v_rcp_f32 v145, v145
  v_rcp_f32 v146, v146
  v_rcp_f32 v147, v147
  v_rcp_f32 v148, v148
  v_rcp_f32 v149, v149
  v_rcp_f32 v150, v150
  v_rcp_f32 v151, v151
  v_pk_mul_f32 v[32:33], v[32:33], v[144:145]
  v_pk_mul_f32 v[34:35], v[34:35], v[146:147]
  buffer_load_dwordx4 a[200:203], v2, s[32:35], s73 offen offset:0 sc1
  v_pk_mul_f32 v[36:37], v[36:37], v[148:149]
  v_pk_mul_f32 v[38:39], v[38:39], v[150:151]
  v_cvt_pk_bf16_f32 v156, v32, v33
  v_cvt_pk_bf16_f32 v157, v34, v35
  v_cvt_pk_bf16_f32 v158, v36, v37
  v_cvt_pk_bf16_f32 v159, v38, v39
  buffer_store_dwordx4 v[152:155], v2, s[32:35], s80 offen offset:2048 sc1
  buffer_store_dwordx4 v[156:159], v2, s[32:35], s81 offen offset:2048 sc1
  buffer_load_dwordx4 a[204:207], v2, s[32:35], s73 offen offset:3072 sc1
  buffer_load_dwordx4 a[208:211], v2, s[32:35], s70 offen offset:0 sc1
  buffer_load_dwordx4 a[212:215], v2, s[32:35], s70 offen offset:3072 sc1
  v_add_u32 v159, 0, v1
  v_mul_u32_u24 v15, 6554, v159
  v_lshrrev_b32 v15, 16, v15
  v_mul_u32_u24 v156, 1120, v15
  v_lshl_add_u32 v156, v159, 4, v156
  v_add_u32 v159, 64, v1
  v_mul_u32_u24 v15, 6554, v159
  v_lshrrev_b32 v15, 16, v15
  v_mul_u32_u24 v157, 1120, v15
  v_lshl_add_u32 v157, v159, 4, v157
  v_add_u32 v159, 128, v1
  v_mul_u32_u24 v15, 6554, v159
  v_lshrrev_b32 v15, 16, v15
  v_mul_u32_u24 v158, 1120, v15
  v_lshl_add_u32 v158, v159, 4, v158
  s_waitcnt vmcnt(11)
  v_mfma_f32_16x16x32_bf16 v[16:19], a[0:3], a[176:179], 0
  v_mfma_f32_16x16x32_bf16 v[20:23], a[4:7], a[176:179], 0
  v_mfma_f32_16x16x32_bf16 v[24:27], a[8:11], a[176:179], 0
  buffer_load_dwordx4 a[216:219], v2, s[32:35], s74 offen offset:0 sc1
  v_mfma_f32_16x16x32_bf16 v[28:31], a[12:15], a[176:179], 0
  v_mfma_f32_16x16x32_bf16 v[32:35], a[16:19], a[176:179], 0
  buffer_load_dword v225, v14, s[32:35], s84 offen offset:128 sc1
  s_waitcnt vmcnt(12)
  v_mfma_f32_16x16x32_bf16 v[16:19], a[20:23], a[180:183], v[16:19]
  v_mfma_f32_16x16x32_bf16 v[20:23], a[24:27], a[180:183], v[20:23]
  v_mfma_f32_16x16x32_bf16 v[24:27], a[28:31], a[180:183], v[24:27]
  buffer_load_dwordx4 a[220:223], v2, s[32:35], s74 offen offset:3072 sc1
  v_mfma_f32_16x16x32_bf16 v[28:31], a[32:35], a[180:183], v[28:31]
  v_mfma_f32_16x16x32_bf16 v[32:35], a[36:39], a[180:183], v[32:35]
  s_waitcnt vmcnt(6)
  s_barrier
  s_cmp_eq_u32 s3, 0
  s_cbranch_scc0 AS_65
  s_mov_b64 exec, 15
  buffer_store_dword v235, v229, s[32:35], s85 offen offset:256 sc1
  s_mov_b64 exec, -1
AS_65:
  v_mfma_f32_16x16x32_bf16 v[16:19], a[40:43], a[184:187], v[16:19]
  v_mfma_f32_16x16x32_bf16 v[20:23], a[44:47], a[184:187], v[20:23]
  v_mfma_f32_16x16x32_bf16 v[24:27], a[48:51], a[184:187], v[24:27]
  buffer_load_dwordx4 a[224:227], v2, s[32:35], s71 offen offset:0 sc1
  v_mfma_f32_16x16x32_bf16 v[28:31], a[52:55], a[184:187], v[28:31]
  v_mfma_f32_16x16x32_bf16 v[32:35], a[56:59], a[184:187], v[32:35]
  v_mfma_f32_16x16x32_bf16 v[16:19], a[60:63], a[188:191], v[16:19]
  v_mfma_f32_16x16x32_bf16 v[20:23], a[64:67], a[188:191], v[20:23]
  v_mfma_f32_16x16x32_bf16 v[24:27], a[68:71], a[188:191], v[24:27]
  buffer_load_dwordx4 a[228:231], v2, s[32:35], s71 offen offset:3072 sc1
  v_mfma_f32_16x16x32_bf16 v[28:31], a[72:75], a[188:191], v[28:31]
  v_mfma_f32_16x16x32_bf16 v[32:35], a[76:79], a[188:191], v[32:35]
  v_mfma_f32_16x16x32_bf16 v[36:39], a[0:3], a[192:195], 0
  v_mfma_f32_16x16x32_bf16 v[40:43], a[4:7], a[192:195], 0
  v_mfma_f32_16x16x32_bf16 v[44:47], a[8:11], a[192:195], 0
  buffer_load_dwordx4 a[232:235], v2, s[32:35], s75 offen offset:0 sc1
  v_mfma_f32_16x16x32_bf16 v[48:51], a[12:15], a[192:195], 0
  v_mfma_f32_16x16x32_bf16 v[52:55], a[16:19], a[192:195], 0
  v_mfma_f32_16x16x32_bf16 v[36:39], a[20:23], a[196:199], v[36:39]
  v_mfma_f32_16x16x32_bf16 v[40:43], a[24:27], a[196:199], v[40:43]
  v_mfma_f32_16x16x32_bf16 v[44:47], a[28:31], a[196:199], v[44:47]
  buffer_load_dwordx4 a[236:239], v2, s[32:35], s75 offen offset:3072 sc1
  v_mfma_f32_16x16x32_bf16 v[48:51], a[32:35], a[196:199], v[48:51]
  v_mfma_f32_16x16x32_bf16 v[52:55], a[36:39], a[196:199], v[52:55]
  s_waitcnt vmcnt(5)
  v_cmp_ne_u32 vcc, s4, v225
  s_add_u32 s7, s84, 128
  s_cbranch_vccz FOK_66
  s_mov_b64 exec, vcc
  s_movk_i32 s5, 0
POLL_67:
  buffer_load_dword v15, v14, s[32:35], s7 offen sc1
  s_addk_i32 s5, 1
  s_waitcnt vmcnt(0)
  v_cmp_ne_u32 vcc, s4, v15
  s_cmpk_ge_u32 s5, 20000
  s_cbranch_scc1 POLLX_68
  s_cbranch_vccz POLLX_68
  s_mov_b64 exec, vcc
  s_sleep 2
  s_branch POLL_67
POLLX_68:
  s_mov_b64 exec, -1
FOK_66:
  v_mfma_f32_16x16x32_bf16 v[36:39], a[40:43], a[200:203], v[36:39]
  v_mfma_f32_16x16x32_bf16 v[40:43], a[44:47], a[200:203], v[40:43]
  v_mfma_f32_16x16x32_bf16 v[44:47], a[48:51], a[200:203], v[44:47]
  s_add_u32 s68, s68, 1024
  s_add_u32 s72, s72, 1024
  buffer_load_dwordx4 a[240:243], v2, s[32:35], s68 offen offset:0 sc1
  v_mfma_f32_16x16x32_bf16 v[48:51], a[52:55], a[200:203], v[48:51]
  v_mfma_f32_16x16x32_bf16 v[52:55], a[56:59], a[200:203], v[52:55]
  v_mfma_f32_16x16x32_bf16 v[36:39], a[60:63], a[204:207], v[36:39]
  v_mfma_f32_16x16x32_bf16 v[40:43], a[64:67], a[204:207], v[40:43]
  v_mfma_f32_16x16x32_bf16 v[44:47], a[68:71], a[204:207], v[44:47]
  buffer_load_dwordx4 a[244:247], v2, s[32:35], s68 offen offset:3072 sc1
  v_mfma_f32_16x16x32_bf16 v[48:51], a[72:75], a[204:207], v[48:51]
  v_mfma_f32_16x16x32_bf16 v[52:55], a[76:79], a[204:207], v[52:55]
  v_mfma_f32_16x16x32_bf16 v[56:59], a[0:3], a[208:211], 0
  v_mfma_f32_16x16x32_bf16 v[60:63], a[4:7], a[208:211], 0
  v_mfma_f32_16x16x32_bf16 v[64:67], a[8:11], a[208:211], 0
  buffer_load_dwordx4 a[248:251], v2, s[32:35], s72 offen offset:0 sc1
  v_mfma_f32_16x16x32_bf16 v[68:71], a[12:15], a[208:211], 0
  v_mfma_f32_16x16x32_bf16 v[72:75], a[16:19], a[208:211], 0
  v_mfma_f32_16x16x32_bf16 v[56:59], a[20:23], a[212:215], v[56:59]
  v_mfma_f32_16x16x32_bf16 v[60:63], a[24:27], a[212:215], v[60:63]
  v_mfma_f32_16x16x32_bf16 v[64:67], a[28:31], a[212:215], v[64:67]
  buffer_load_dwordx4 a[252:255], v2, s[32:35], s72 offen offset:3072 sc1
  v_mfma_f32_16x16x32_bf16 v[68:71], a[32:35], a[212:215], v[68:71]
  v_mfma_f32_16x16x32_bf16 v[72:75], a[36:39], a[212:215], v[72:75]
  v_mfma_f32_16x16x32_bf16 v[56:59], a[40:43], a[216:219], v[56:59]
  v_mfma_f32_16x16x32_bf16 v[60:63], a[44:47], a[216:219], v[60:63]
  v_mfma_f32_16x16x32_bf16 v[64:67], a[48:51], a[216:219], v[64:67]
  s_add_u32 s69, s69, 1024
  s_add_u32 s73, s73, 1024
  buffer_load_dwordx4 a[176:179], v2, s[32:35], s69 offen offset:0 sc1
  v_mfma_f32_16x16x32_bf16 v[68:71], a[52:55], a[216:219], v[68:71]
  v_mfma_f32_16x16x32_bf16 v[72:75], a[56:59], a[216:219], v[72:75]
  s_waitcnt vmcnt(9)
  v_mfma_f32_16x16x32_bf16 v[56:59], a[60:63], a[220:223], v[56:59]
  v_mfma_f32_16x16x32_bf16 v[60:63], a[64:67], a[220:223], v[60:63]
  v_mfma_f32_16x16x32_bf16 v[64:67], a[68:71], a[220:223], v[64:67]
  buffer_load_dwordx4 a[180:183], v2, s[32:35], s69 offen offset:3072 sc1
  v_mfma_f32_16x16x32_bf16 v[68:71], a[72:75], a[220:223], v[68:71]
  v_mfma_f32_16x16x32_bf16 v[72:75], a[76:79], a[220:223], v[72:75]
  s_waitcnt vmcnt(9)
  v_mfma_f32_16x16x32_bf16 v[76:79], a[0:3], a[224:227], 0
  v_mfma_f32_16x16x32_bf16 v[80:83], a[4:7], a[224:227], 0
  v_mfma_f32_16x16x32_bf16 v[84:87], a[8:11], a[224:227], 0
  buffer_load_dwordx4 a[184:187], v2, s[32:35], s73 offen offset:0 sc1
  v_mfma_f32_16x16x32_bf16 v[88:91], a[12:15], a[224:227], 0
  v_mfma_f32_16x16x32_bf16 v[92:95], a[16:19], a[224:227], 0
  buffer_load_dword v226, v14, s[32:35], s84 offen offset:256 sc1
  s_waitcnt vmcnt(10)
  v_mfma_f32_16x16x32_bf16 v[76:79], a[20:23], a[228:231], v[76:79]
  v_mfma_f32_16x16x32_bf16 v[80:83], a[24:27], a[228:231], v[80:83]
  v_mfma_f32_16x16x32_bf16 v[84:87], a[28:31], a[228:231], v[84:87]
  buffer_load_dwordx4 a[188:191], v2, s[32:35], s73 offen offset:3072 sc1
  v_mfma_f32_16x16x32_bf16 v[88:91], a[32:35], a[228:231], v[88:91]
  v_mfma_f32_16x16x32_bf16 v[92:95], a[36:39], a[228:231], v[92:95]
  s_waitcnt vmcnt(10)
  v_mfma_f32_16x16x32_bf16 v[76:79], a[40:43], a[232:235], v[76:79]
  v_mfma_f32_16x16x32_bf16 v[80:83], a[44:47], a[232:235], v[80:83]
  v_mfma_f32_16x16x32_bf16 v[84:87], a[48:51], a[232:235], v[84:87]
  s_add_u32 s70, s70, 1024
  s_add_u32 s74, s74, 1024
  buffer_load_dwordx4 a[192:195], v2, s[32:35], s70 offen offset:0 sc1
  v_mfma_f32_16x16x32_bf16 v[88:91], a[52:55], a[232:235], v[88:91]
  v_mfma_f32_16x16x32_bf16 v[92:95], a[56:59], a[232:235], v[92:95]
  s_waitcnt vmcnt(10)
  v_mfma_f32_16x16x32_bf16 v[76:79], a[60:63], a[236:239], v[76:79]
  v_mfma_f32_16x16x32_bf16 v[80:83], a[64:67], a[236:239], v[80:83]
  v_mfma_f32_16x16x32_bf16 v[84:87], a[68:71], a[236:239], v[84:87]
  buffer_load_dwordx4 a[196:199], v2, s[32:35], s70 offen offset:3072 sc1
  v_mfma_f32_16x16x32_bf16 v[88:91], a[72:75], a[236:239], v[88:91]
  v_mfma_f32_16x16x32_bf16 v[92:95], a[76:79], a[236:239], v[92:95]
  s_waitcnt vmcnt(10)
  v_mfma_f32_16x16x32_bf16 v[16:19], a[80:83], a[240:243], v[16:19]
  v_mfma_f32_16x16x32_bf16 v[20:23], a[84:87], a[240:243], v[20:23]
  v_mfma_f32_16x16x32_bf16 v[24:27], a[88:91], a[240:243], v[24:27]
  buffer_load_dwordx4 a[200:203], v2, s[32:35], s74 offen offset:0 sc1
  v_mfma_f32_16x16x32_bf16 v[28:31], a[92:95], a[240:243], v[28:31]
  v_mfma_f32_16x16x32_bf16 v[32:35], v[160:163], a[240:243], v[32:35]
  s_waitcnt vmcnt(10)
  v_mfma_f32_16x16x32_bf16 v[16:19], v[164:167], a[244:247], v[16:19]
  v_mfma_f32_16x16x32_bf16 v[20:23], v[168:171], a[244:247], v[20:23]
  v_mfma_f32_16x16x32_bf16 v[24:27], v[172:175], a[244:247], v[24:27]
  buffer_load_dwordx4 a[204:207], v2, s[32:35], s74 offen offset:3072 sc1
  v_mfma_f32_16x16x32_bf16 v[28:31], v[176:179], a[244:247], v[28:31]
  v_mfma_f32_16x16x32_bf16 v[32:35], v[180:183], a[244:247], v[32:35]
  s_waitcnt vmcnt(10)
  v_mfma_f32_16x16x32_bf16 v[16:19], v[184:187], a[248:251], v[16:19]
  v_mfma_f32_16x16x32_bf16 v[20:23], v[188:191], a[248:251], v[20:23]
  v_mfma_f32_16x16x32_bf16 v[24:27], v[192:195], a[248:251], v[24:27]
  v_mfma_f32_16x16x32_bf16 v[28:31], v[196:199], a[248:251], v[28:31]
  v_mfma_f32_16x16x32_bf16 v[32:35], v[200:203], a[248:251], v[32:35]
  s_waitcnt vmcnt(9)
  v_mfma_f32_16x16x32_bf16 v[16:19], v[204:207], a[252:255], v[16:19]
  v_mfma_f32_16x16x32_bf16 v[20:23], v[208:211], a[252:255], v[20:23]
  v_mfma_f32_16x16x32_bf16 v[24:27], v[212:215], a[252:255], v[24:27]
  v_mfma_f32_16x16x32_bf16 v[28:31], v[216:219], a[252:255], v[28:31]
  v_mfma_f32_16x16x32_bf16 v[32:35], v[220:223], a[252:255], v[32:35]
  s_waitcnt vmcnt(8)
  v_mfma_f32_16x16x32_bf16 v[36:39], a[80:83], a[176:179], v[36:39]
  v_mfma_f32_16x16x32_bf16 v[40:43], a[84:87], a[176:179], v[40:43]
  v_mfma_f32_16x16x32_bf16 v[44:47], a[88:91], a[176:179], v[44:47]
  v_mfma_f32_16x16x32_bf16 v[48:51], a[92:95], a[176:179], v[48:51]
  v_mfma_f32_16x16x32_bf16 v[52:55], v[160:163], a[176:179], v[52:55]
  s_waitcnt vmcnt(7)
  v_mfma_f32_16x16x32_bf16 v[36:39], v[164:167], a[180:183], v[36:39]
  v_mfma_f32_16x16x32_bf16 v[40:43], v[168:171], a[180:183], v[40:43]
  v_mfma_f32_16x16x32_bf16 v[44:47], v[172:175], a[180:183], v[44:47]
  v_mfma_f32_16x16x32_bf16 v[48:51], v[176:179], a[180:183], v[48:51]
  v_mfma_f32_16x16x32_bf16 v[52:55], v[180:183], a[180:183], v[52:55]
  s_waitcnt vmcnt(5)
  v_cmp_ne_u32 vcc, s4, v226
  s_add_u32 s7, s84, 256
  s_cbranch_vccz FOK_69
  s_mov_b64 exec, vcc
  s_movk_i32 s5, 0
POLL_70:
  buffer_load_dword v15, v14, s[32:35], s7 offen sc1
  s_addk_i32 s5, 1
  s_waitcnt vmcnt(0)
  v_cmp_ne_u32 vcc, s4, v15
  s_cmpk_ge_u32 s5, 20000
  s_cbranch_scc1 POLLX_71
  s_cbranch_vccz POLLX_71
  s_mov_b64 exec, vcc
  s_sleep 2
  s_branch POLL_70
POLLX_71:
  s_mov_b64 exec, -1
FOK_69:
  v_mfma_f32_16x16x32_bf16 v[36:39], v[184:187], a[184:187], v[36:39]
  s_add_u32 s68, s68, 1024
  s_add_u32 s72, s72, 1024
  buffer_load_dwordx4 a[208:211], v2, s[32:35], s68 offen offset:0 sc1
  v_mfma_f32_16x16x32_bf16 v[40:43], v[188:191], a[184:187], v[40:43]
  buffer_load_dwordx4 a[212:215], v2, s[32:35], s68 offen offset:3072 sc1
  v_mfma_f32_16x16x32_bf16 v[44:47], v[192:195], a[184:187], v[44:47]
  buffer_load_dwordx4 a[216:219], v2, s[32:35], s72 offen offset:0 sc1
  v_mfma_f32_16x16x32_bf16 v[48:51], v[196:199], a[184:187], v[48:51]
  v_mfma_f32_16x16x32_bf16 v[52:55], v[200:203], a[184:187], v[52:55]
  s_waitcnt vmcnt(7)
  v_mfma_f32_16x16x32_bf16 v[36:39], v[204:207], a[188:191], v[36:39]
  buffer_load_dwordx4 a[220:223], v2, s[32:35], s72 offen offset:3072 sc1
  v_mfma_f32_16x16x32_bf16 v[40:43], v[208:211], a[188:191], v[40:43]
  v_mfma_f32_16x16x32_bf16 v[44:47], v[212:215], a[188:191], v[44:47]
  s_add_u32 s69, s69, 1024
  s_add_u32 s73, s73, 1024
  buffer_load_dwordx4 a[224:227], v2, s[32:35], s69 offen offset:0 sc1
  v_mfma_f32_16x16x32_bf16 v[48:51], v[216:219], a[188:191], v[48:51]
  v_mfma_f32_16x16x32_bf16 v[52:55], v[220:223], a[188:191], v[52:55]
  s_waitcnt vmcnt(8)
  v_mfma_f32_16x16x32_bf16 v[56:59], a[80:83], a[192:195], v[56:59]
  v_mfma_f32_16x16x32_bf16 v[60:63], a[84:87], a[192:195], v[60:63]
  v_mfma_f32_16x16x32_bf16 v[64:67], a[88:91], a[192:195], v[64:67]
  buffer_load_dwordx4 a[228:231], v2, s[32:35], s69 offen offset:3072 sc1
  v_mfma_f32_16x16x32_bf16 v[68:71], a[92:95], a[192:195], v[68:71]
  v_mfma_f32_16x16x32_bf16 v[72:75], v[160:163], a[192:195], v[72:75]
  s_waitcnt vmcnt(8)
  v_mfma_f32_16x16x32_bf16 v[56:59], v[164:167], a[196:199], v[56:59]
  v_mfma_f32_16x16x32_bf16 v[60:63], v[168:171], a[196:199], v[60:63]
  v_mfma_f32_16x16x32_bf16 v[64:67], v[172:175], a[196:199], v[64:67]
  buffer_load_dwordx4 a[232:235], v2, s[32:35], s73 offen offset:0 sc1
  v_mfma_f32_16x16x32_bf16 v[68:71], v[176:179], a[196:199], v[68:71]
  v_mfma_f32_16x16x32_bf16 v[72:75], v[180:183], a[196:199], v[72:75]
  s_waitcnt vmcnt(8)
  v_mfma_f32_16x16x32_bf16 v[56:59], v[184:187], a[200:203], v[56:59]
  v_mfma_f32_16x16x32_bf16 v[60:63], v[188:191], a[200:203], v[60:63]
  v_mfma_f32_16x16x32_bf16 v[64:67], v[192:195], a[200:203], v[64:67]
  buffer_load_dwordx4 a[236:239], v2, s[32:35], s73 offen offset:3072 sc1
  v_mfma_f32_16x16x32_bf16 v[68:71], v[196:199], a[200:203], v[68:71]
  v_mfma_f32_16x16x32_bf16 v[72:75], v[200:203], a[200:203], v[72:75]
  s_waitcnt vmcnt(8)
  v_mfma_f32_16x16x32_bf16 v[56:59], v[204:207], a[204:207], v[56:59]
  v_mfma_f32_16x16x32_bf16 v[60:63], v[208:211], a[204:207], v[60:63]
  v_mfma_f32_16x16x32_bf16 v[64:67], v[212:215], a[204:207], v[64:67]
  s_add_u32 s70, s70, 1024
  s_add_u32 s74, s74, 1024
  buffer_load_dwordx4 a[240:243], v2, s[32:35], s70 offen offset:0 sc1
  v_mfma_f32_16x16x32_bf16 v[68:71], v[216:219], a[204:207], v[68:71]
  v_mfma_f32_16x16x32_bf16 v[72:75], v[220:223], a[204:207], v[72:75]
  s_waitcnt vmcnt(8)
  v_mfma_f32_16x16x32_bf16 v[16:19], a[96:99], a[208:211], v[16:19]
  v_mfma_f32_16x16x32_bf16 v[20:23], a[100:103], a[208:211], v[20:23]
  v_mfma_f32_16x16x32_bf16 v[24:27], a[104:107], a[208:211], v[24:27]
  buffer_load_dwordx4 a[244:247], v2, s[32:35], s70 offen offset:3072 sc1
  v_mfma_f32_16x16x32_bf16 v[28:31], a[108:111], a[208:211], v[28:31]
  v_mfma_f32_16x16x32_bf16 v[32:35], a[112:115], a[208:211], v[32:35]
  s_waitcnt vmcnt(8)
  v_mfma_f32_16x16x32_bf16 v[16:19], a[116:119], a[212:215], v[16:19]
  v_mfma_f32_16x16x32_bf16 v[20:23], a[120:123], a[212:215], v[20:23]
  v_mfma_f32_16x16x32_bf16 v[24:27], a[124:127], a[212:215], v[24:27]
  buffer_load_dwordx4 a[248:251], v2, s[32:35], s74 offen offset:0 sc1
  v_mfma_f32_16x16x32_bf16 v[28:31], a[128:131], a[212:215], v[28:31]
  v_mfma_f32_16x16x32_bf16 v[32:35], a[132:135], a[212:215], v[32:35]
  s_waitcnt vmcnt(8)
  v_mfma_f32_16x16x32_bf16 v[16:19], a[136:139], a[216:219], v[16:19]
  v_mfma_f32_16x16x32_bf16 v[20:23], a[140:143], a[216:219], v[20:23]
  v_mfma_f32_16x16x32_bf16 v[24:27], a[144:147], a[216:219], v[24:27]
  buffer_load_dwordx4 a[252:255], v2, s[32:35], s74 offen offset:3072 sc1
  v_mfma_f32_16x16x32_bf16 v[28:31], a[148:151], a[216:219], v[28:31]
  v_mfma_f32_16x16x32_bf16 v[32:35], a[152:155], a[216:219], v[32:35]
  s_waitcnt vmcnt(8)
  v_mfma_f32_16x16x32_bf16 v[16:19], a[156:159], a[220:223], v[16:19]
  v_mfma_f32_16x16x32_bf16 v[20:23], a[160:163], a[220:223], v[20:23]
  v_mfma_f32_16x16x32_bf16 v[24:27], a[164:167], a[220:223], v[24:27]
  s_add_u32 s71, s71, 1024
  s_add_u32 s75, s75, 1024
  buffer_load_dwordx4 a[176:179], v2, s[32:35], s71 offen offset:0 sc1
  v_mfma_f32_16x16x32_bf16 v[28:31], a[168:171], a[220:223], v[28:31]
  v_mfma_f32_16x16x32_bf16 v[32:35], a[172:175], a[220:223], v[32:35]
  s_waitcnt vmcnt(8)
  v_mfma_f32_16x16x32_bf16 v[36:39], a[96:99], a[224:227], v[36:39]
  v_mfma_f32_16x16x32_bf16 v[40:43], a[100:103], a[224:227], v[40:43]
  v_mfma_f32_16x16x32_bf16 v[44:47], a[104:107], a[224:227], v[44:47]
  buffer_load_dwordx4 a[180:183], v2, s[32:35], s71 offen offset:3072 sc1
  v_mfma_f32_16x16x32_bf16 v[48:51], a[108:111], a[224:227], v[48:51]
  ds_write_b128 v8, v[16:19] offset:0
  v_mfma_f32_16x16x32_bf16 v[52:55], a[112:115], a[224:227], v[52:55]
  s_waitcnt vmcnt(8)
  v_mfma_f32_16x16x32_bf16 v[36:39], a[116:119], a[228:231], v[36:39]
  v_mfma_f32_16x16x32_bf16 v[40:43], a[120:123], a[228:231], v[40:43]
  ds_write_b128 v8, v[20:23] offset:1024
  v_mfma_f32_16x16x32_bf16 v[44:47], a[124:127], a[228:231], v[44:47]
  buffer_load_dwordx4 a[184:187], v2, s[32:35], s75 offen offset:0 sc1
  v_mfma_f32_16x16x32_bf16 v[48:51], a[128:131], a[228:231], v[48:51]
  v_mfma_f32_16x16x32_bf16 v[52:55], a[132:135], a[228:231], v[52:55]
  s_waitcnt vmcnt(8)
  v_mfma_f32_16x16x32_bf16 v[36:39], a[136:139], a[232:235], v[36:39]
  ds_write_b128 v8, v[24:27] offset:2048
  v_mfma_f32_16x16x32_bf16 v[40:43], a[140:143], a[232:235], v[40:43]
  v_mfma_f32_16x16x32_bf16 v[44:47], a[144:147], a[232:235], v[44:47]
  buffer_load_dwordx4 a[188:191], v2, s[32:35], s75 offen offset:3072 sc1
  v_mfma_f32_16x16x32_bf16 v[48:51], a[148:151], a[232:235], v[48:51]
  v_mfma_f32_16x16x32_bf16 v[52:55], a[152:155], a[232:235], v[52:55]
  ds_write_b128 v8, v[28:31] offset:3072
  s_waitcnt vmcnt(8)
  v_mfma_f32_16x16x32_bf16 v[36:39], a[156:159], a[236:239], v[36:39]
  v_mfma_f32_16x16x32_bf16 v[40:43], a[160:163], a[236:239], v[40:43]
  v_mfma_f32_16x16x32_bf16 v[44:47], a[164:167], a[236:239], v[44:47]
  s_add_u32 s71, s71, 1024
  s_add_u32 s75, s75, 1024
  buffer_load_dwordx4 a[192:195], v2, s[32:35], s71 offen offset:0 sc1
  v_mfma_f32_16x16x32_bf16 v[48:51], a[168:171], a[236:239], v[48:51]
  ds_write_b128 v8, v[32:35] offset:4096
  v_mfma_f32_16x16x32_bf16 v[52:55], a[172:175], a[236:239], v[52:55]
  s_waitcnt vmcnt(8)
  v_mfma_f32_16x16x32_bf16 v[56:59], a[96:99], a[240:243], v[56:59]
  v_mfma_f32_16x16x32_bf16 v[60:63], a[100:103], a[240:243], v[60:63]
  v_mfma_f32_16x16x32_bf16 v[64:67], a[104:107], a[240:243], v[64:67]
  buffer_load_dwordx4 a[196:199], v2, s[32:35], s71 offen offset:3072 sc1
  v_mfma_f32_16x16x32_bf16 v[68:71], a[108:111], a[240:243], v[68:71]
  v_mfma_f32_16x16x32_bf16 v[72:75], a[112:115], a[240:243], v[72:75]
  ds_write_b128 v9, v[36:39] offset:0
  s_waitcnt vmcnt(8)
  v_mfma_f32_16x16x32_bf16 v[56:59], a[116:119], a[244:247], v[56:59]
  v_mfma_f32_16x16x32_bf16 v[60:63], a[120:123], a[244:247], v[60:63]
  v_mfma_f32_16x16x32_bf16 v[64:67], a[124:127], a[244:247], v[64:67]
  buffer_load_dwordx4 a[200:203], v2, s[32:35], s75 offen offset:0 sc1
  v_mfma_f32_16x16x32_bf16 v[68:71], a[128:131], a[244:247], v[68:71]
  ds_write_b128 v9, v[40:43] offset:1024
  v_mfma_f32_16x16x32_bf16 v[72:75], a[132:135], a[244:247], v[72:75]
  s_waitcnt vmcnt(8)
  v_mfma_f32_16x16x32_bf16 v[56:59], a[136:139], a[248:251], v[56:59]
  v_mfma_f32_16x16x32_bf16 v[60:63], a[140:143], a[248:251], v[60:63]
  ds_write_b128 v9, v[44:47] offset:2048
  v_mfma_f32_16x16x32_bf16 v[64:67], a[144:147], a[248:251], v[64:67]
  buffer_load_dwordx4 a[204:207], v2, s[32:35], s75 offen offset:3072 sc1
  v_mfma_f32_16x16x32_bf16 v[68:71], a[148:151], a[248:251], v[68:71]
  v_mfma_f32_16x16x32_bf16 v[72:75], a[152:155], a[248:251], v[72:75]
  s_waitcnt vmcnt(8)
  v_mfma_f32_16x16x32_bf16 v[56:59], a[156:159], a[252:255], v[56:59]
  ds_write_b128 v9, v[48:51] offset:3072
  v_mfma_f32_16x16x32_bf16 v[60:63], a[160:163], a[252:255], v[60:63]
  v_mfma_f32_16x16x32_bf16 v[64:67], a[164:167], a[252:255], v[64:67]
  v_mfma_f32_16x16x32_bf16 v[68:71], a[168:171], a[252:255], v[68:71]
  ds_write_b128 v9, v[52:55] offset:4096
  v_mfma_f32_16x16x32_bf16 v[72:75], a[172:175], a[252:255], v[72:75]
  s_waitcnt vmcnt(7)
  v_mfma_f32_16x16x32_bf16 v[76:79], a[80:83], a[176:179], v[76:79]
  v_mfma_f32_16x16x32_bf16 v[80:83], a[84:87], a[176:179], v[80:83]
  s_waitcnt lgkmcnt(5)
  v_mfma_f32_16x16x32_bf16 v[84:87], a[88:91], a[176:179], v[84:87]
  v_lshlrev_b32 v16, 16, v246
  v_and_b32 v17, 0xffff0000, v246
  v_mfma_f32_16x16x32_bf16 v[88:91], a[92:95], a[176:179], v[88:91]
  v_lshlrev_b32 v18, 16, v247
  v_and_b32 v19, 0xffff0000, v247
  v_mfma_f32_16x16x32_bf16 v[92:95], v[160:163], a[176:179], v[92:95]
  v_lshlrev_b32 v20, 16, v248
  v_and_b32 v21, 0xffff0000, v248
  s_waitcnt vmcnt(6)
  v_mfma_f32_16x16x32_bf16 v[76:79], v[164:167], a[180:183], v[76:79]
  v_lshlrev_b32 v22, 16, v249
  v_and_b32 v23, 0xffff0000, v249
  v_mfma_f32_16x16x32_bf16 v[80:83], v[168:171], a[180:183], v[80:83]
  v_lshlrev_b32 v24, 16, v250
  v_and_b32 v25, 0xffff0000, v250
  v_mfma_f32_16x16x32_bf16 v[84:87], v[172:175], a[180:183], v[84:87]
  v_lshlrev_b32 v26, 16, v251
  v_and_b32 v27, 0xffff0000, v251
  v_mfma_f32_16x16x32_bf16 v[88:91], v[176:179], a[180:183], v[88:91]
  v_lshlrev_b32 v28, 16, v252
  v_and_b32 v29, 0xffff0000, v252
  v_mfma_f32_16x16x32_bf16 v[92:95], v[180:183], a[180:183], v[92:95]
  v_lshlrev_b32 v30, 16, v253
  v_and_b32 v31, 0xffff0000, v253
  s_waitcnt vmcnt(5)
  v_mfma_f32_16x16x32_bf16 v[76:79], v[184:187], a[184:187], v[76:79]
  v_lshlrev_b32 v32, 16, v254
  v_and_b32 v33, 0xffff0000, v254
  v_mfma_f32_16x16x32_bf16 v[80:83], v[188:191], a[184:187], v[80:83]
  v_lshlrev_b32 v34, 16, v255
  v_and_b32 v35, 0xffff0000, v255
  v_mfma_f32_16x16x32_bf16 v[84:87], v[192:195], a[184:187], v[84:87]
  v_mfma_f32_16x16x32_bf16 v[88:91], v[196:199], a[184:187], v[88:91]
  v_mfma_f32_16x16x32_bf16 v[92:95], v[200:203], a[184:187], v[92:95]
  ds_write_b128 v10, v[56:59] offset:0
  s_waitcnt vmcnt(4)
  v_mfma_f32_16x16x32_bf16 v[76:79], v[204:207], a[188:191], v[76:79]
  v_mfma_f32_16x16x32_bf16 v[80:83], v[208:211], a[188:191], v[80:83]
  v_mfma_f32_16x16x32_bf16 v[84:87], v[212:215], a[188:191], v[84:87]
  ds_write_b128 v10, v[60:63] offset:1024
  v_mfma_f32_16x16x32_bf16 v[88:91], v[216:219], a[188:191], v[88:91]
  v_mfma_f32_16x16x32_bf16 v[92:95], v[220:223], a[188:191], v[92:95]
  s_waitcnt vmcnt(3)
  v_mfma_f32_16x16x32_bf16 v[76:79], a[96:99], a[192:195], v[76:79]
  ds_write_b128 v10, v[64:67] offset:2048
  v_mfma_f32_16x16x32_bf16 v[80:83], a[100:103], a[192:195], v[80:83]
  v_mfma_f32_16x16x32_bf16 v[84:87], a[104:107], a[192:195], v[84:87]
  v_mfma_f32_16x16x32_bf16 v[88:91], a[108:111], a[192:195], v[88:91]
  ds_write_b128 v10, v[68:71] offset:3072
  v_mfma_f32_16x16x32_bf16 v[92:95], a[112:115], a[192:195], v[92:95]
  s_waitcnt vmcnt(2)
  v_mfma_f32_16x16x32_bf16 v[76:79], a[116:119], a[196:199], v[76:79]
  v_mfma_f32_16x16x32_bf16 v[80:83], a[120:123], a[196:199], v[80:83]
  ds_write_b128 v10, v[72:75] offset:4096
  v_mfma_f32_16x16x32_bf16 v[84:87], a[124:127], a[196:199], v[84:87]
  v_mfma_f32_16x16x32_bf16 v[88:91], a[128:131], a[196:199], v[88:91]
  v_mfma_f32_16x16x32_bf16 v[92:95], a[132:135], a[196:199], v[92:95]
  s_waitcnt vmcnt(1)
  v_mfma_f32_16x16x32_bf16 v[76:79], a[136:139], a[200:203], v[76:79]
  s_waitcnt lgkmcnt(0)
  s_barrier
  v_mfma_f32_16x16x32_bf16 v[80:83], a[140:143], a[200:203], v[80:83]
  ds_read_b128 v[96:99], v11 offset:0
  ds_read_b128 v[100:103], v11 offset:1024
  v_mfma_f32_16x16x32_bf16 v[84:87], a[144:147], a[200:203], v[84:87]
  ds_read_b128 v[104:107], v11 offset:2048
  ds_read_b128 v[108:111], v11 offset:3072
  v_mfma_f32_16x16x32_bf16 v[88:91], a[148:151], a[200:203], v[88:91]
  ds_read_b128 v[112:115], v11 offset:4096
  ds_read_b128 v[116:119], v11 offset:5120
  v_mfma_f32_16x16x32_bf16 v[92:95], a[152:155], a[200:203], v[92:95]
  ds_read_b128 v[120:123], v11 offset:6144
  ds_read_b128 v[124:127], v11 offset:7168
  s_waitcnt vmcnt(0)
  v_mfma_f32_16x16x32_bf16 v[76:79], a[156:159], a[204:207], v[76:79]
  ds_read_b128 v[128:131], v11 offset:8192
  ds_read_b128 v[132:135], v11 offset:9216
  v_mfma_f32_16x16x32_bf16 v[80:83], a[160:163], a[204:207], v[80:83]
  ds_read_b128 v[136:139], v11 offset:10240
  ds_read_b128 v[140:143], v11 offset:11264
  v_mfma_f32_16x16x32_bf16 v[84:87], a[164:167], a[204:207], v[84:87]
  ds_read_b128 v[144:147], v11 offset:12288
  ds_read_b128 v[148:151], v11 offset:13312
  v_mfma_f32_16x16x32_bf16 v[88:91], a[168:171], a[204:207], v[88:91]
  ds_read_b128 v[152:155], v11 offset:14336
  v_lshlrev_b32 v36, 16, v236
  v_mfma_f32_16x16x32_bf16 v[92:95], a[172:175], a[204:207], v[92:95]
  v_and_b32 v37, 0xffff0000, v236
  v_lshlrev_b32 v38, 16, v237
  v_and_b32 v39, 0xffff0000, v237
  v_lshlrev_b32 v40, 16, v238
  v_and_b32 v41, 0xffff0000, v238
  v_lshlrev_b32 v42, 16, v239
  v_and_b32 v43, 0xffff0000, v239
  v_lshlrev_b32 v44, 16, v240
  v_and_b32 v45, 0xffff0000, v240
  v_lshlrev_b32 v46, 16, v241
  v_and_b32 v47, 0xffff0000, v241
  v_lshlrev_b32 v48, 16, v242
  v_and_b32 v49, 0xffff0000, v242
  v_lshlrev_b32 v50, 16, v243
  v_and_b32 v51, 0xffff0000, v243
  v_lshlrev_b32 v52, 16, v244
  v_and_b32 v53, 0xffff0000, v244
  v_lshlrev_b32 v54, 16, v245
  v_and_b32 v55, 0xffff0000, v245
  s_waitcnt lgkmcnt(5)
  v_pk_add_f32 v[96:97], v[96:97], v[116:117]
  v_pk_add_f32 v[98:99], v[98:99], v[118:119]
  v_pk_add_f32 v[100:101], v[100:101], v[120:121]
  v_pk_add_f32 v[102:103], v[102:103], v[122:123]
  v_pk_add_f32 v[104:105], v[104:105], v[124:125]
  v_pk_add_f32 v[106:107], v[106:107], v[126:127]
  v_pk_add_f32 v[108:109], v[108:109], v[128:129]
  v_pk_add_f32 v[110:111], v[110:111], v[130:131]
  v_pk_add_f32 v[112:113], v[112:113], v[132:133]
  v_pk_add_f32 v[114:115], v[114:115], v[134:135]
  s_waitcnt lgkmcnt(0)
  v_pk_add_f32 v[96:97], v[96:97], v[136:137]
  v_pk_add_f32 v[98:99], v[98:99], v[138:139]
  v_pk_add_f32 v[100:101], v[100:101], v[140:141]
  v_pk_add_f32 v[102:103], v[102:103], v[142:143]
  v_pk_add_f32 v[104:105], v[104:105], v[144:145]
  v_pk_add_f32 v[106:107], v[106:107], v[146:147]
  v_pk_add_f32 v[108:109], v[108:109], v[148:149]
  v_pk_add_f32 v[110:111], v[110:111], v[150:151]
  v_pk_add_f32 v[112:113], v[112:113], v[152:153]
  v_pk_add_f32 v[114:115], v[114:115], v[154:155]
  v_pk_fma_f32 v[96:97], v[96:97], v[16:17], v[36:37]
  v_pk_fma_f32 v[98:99], v[98:99], v[18:19], v[38:39]
  v_pk_fma_f32 v[100:101], v[100:101], v[20:21], v[40:41]
  v_pk_fma_f32 v[102:103], v[102:103], v[22:23], v[42:43]
  v_pk_fma_f32 v[104:105], v[104:105], v[24:25], v[44:45]
  v_pk_fma_f32 v[106:107], v[106:107], v[26:27], v[46:47]
  v_pk_fma_f32 v[108:109], v[108:109], v[28:29], v[48:49]
  v_pk_fma_f32 v[110:111], v[110:111], v[30:31], v[50:51]
  v_pk_fma_f32 v[112:113], v[112:113], v[32:33], v[52:53]
  v_pk_fma_f32 v[114:115], v[114:115], v[34:35], v[54:55]
  s_cmp_lg_u32 s2, 0
  s_cbranch_scc1 EP_72
  s_mov_b32 s6, 0
  s_cmp_eq_u32 s3, 2
  s_cbranch_scc0 SIG_73
  s_mov_b64 exec, 1
  buffer_store_dword v235, v2, s[32:35], s6 offen sc1
  s_mov_b64 exec, -1
SIG_73:
EP_72:
  v_pk_fma_f32 v[76:77], v[76:77], v[16:17], v[96:97]
  v_pk_fma_f32 v[78:79], v[78:79], v[18:19], v[98:99]
  v_pk_fma_f32 v[80:81], v[80:81], v[20:21], v[100:101]
  v_pk_fma_f32 v[82:83], v[82:83], v[22:23], v[102:103]
  v_cvt_pk_bf16_f32 v56, v76, v77
  v_cvt_pk_bf16_f32 v57, v78, v79
  v_cvt_pk_bf16_f32 v58, v80, v81
  v_cvt_pk_bf16_f32 v59, v82, v83
  ds_write_b128 v12, v[56:59] offset:0
  v_pk_fma_f32 v[84:85], v[84:85], v[24:25], v[104:105]
  v_pk_fma_f32 v[86:87], v[86:87], v[26:27], v[106:107]
  v_pk_fma_f32 v[88:89], v[88:89], v[28:29], v[108:109]
  v_pk_fma_f32 v[90:91], v[90:91], v[30:31], v[110:111]
  v_cvt_pk_bf16_f32 v60, v84, v85
  v_cvt_pk_bf16_f32 v61, v86, v87
  v_cvt_pk_bf16_f32 v62, v88, v89
  v_cvt_pk_bf16_f32 v63, v90, v91
  ds_write_b128 v12, v[60:63] offset:64
  v_pk_fma_f32 v[92:93], v[92:93], v[32:33], v[112:113]
  v_pk_fma_f32 v[94:95], v[94:95], v[34:35], v[114:115]
  v_cvt_pk_bf16_f32 v64, v92, v93
  v_cvt_pk_bf16_f32 v65, v94, v95
  ds_write_b64 v13, v[64:65] offset:128
  ds_read_b128 v[36:39], v11 offset:0
  ds_read_b128 v[40:43], v11 offset:1024
  ds_read_b128 v[44:47], v11 offset:2048
  s_waitcnt lgkmcnt(2)
  buffer_store_dwordx4 v[36:39], v156, s[40:43], s77 offen
  s_waitcnt lgkmcnt(1)
  buffer_store_dwordx4 v[40:43], v157, s[40:43], s77 offen
  s_waitcnt lgkmcnt(0)
  s_mov_b32 exec_hi, 0
  buffer_store_dwordx4 v[44:47], v158, s[40:43], s77 offen
  s_mov_b64 exec, -1
L_end:
  s_endpgm
.section .rodata,"a"
.p2align 6
.amdhsa_kernel adaLN_cond__sliding_local_dilated__swiglu_ffn__prompt_kernel
  .amdhsa_next_free_vgpr 512
  .amdhsa_next_free_sgpr 102
  .amdhsa_accum_offset 256
  .amdhsa_group_segment_fixed_size 0
  .amdhsa_kernarg_size 96
  .amdhsa_user_sgpr_count 2
  .amdhsa_user_sgpr_kernarg_segment_ptr 1
  .amdhsa_system_sgpr_workgroup_id_x 1
.end_amdhsa_kernel
```
